```python
import torch

def _softmax(x, axis=-1):
    return torch.softmax(x, dim=axis)
def _gelu(x):
    return torch.nn.functional.gelu(x, approximate="tanh")
def _silu(x):
    return torch.nn.functional.silu(x)
def _sigmoid(x):
    return torch.sigmoid(x)
def _layernorm(x, axis=-1, eps=1e-5):
    m = x.mean(dim=axis, keepdim=True)
    v = x.var(dim=axis, keepdim=True, unbiased=False)
    return (x - m) / torch.sqrt(v + eps)
def _scatter_add(tgt, idx, src, axis=0):
    return tgt.clone().index_add_(axis, idx, src)
def _segment_sum(src, seg, n):
    out = torch.zeros((n,) + src.shape[1:], dtype=src.dtype)
    return out.index_add_(0, seg, src)
def _pad(x, pw):
    flat = tuple(v for pair in reversed(pw) for v in pair)
    return torch.nn.functional.pad(x, flat)

kernel_name = 'standalone__sliding_block_cached__sampling'

def setup_inputs():

    _w = (lambda a: (lambda t: t.to(torch.bfloat16) if t.is_floating_point() else t)(torch.as_tensor(a)))
    B, Sq, D = 32, 1, 512
    Hq, Hkv, Sk, Dh = 32, 8, 2048, 128
    assert Hq % Hkv == 0, (Hq, Hkv)
    return {
        "x": _w((lambda *s: torch.randn(*s, dtype=torch.bfloat16) * 0.8)(B, Sq, D)),
        "k_cache": _w((lambda *s: torch.randn(*s, dtype=torch.bfloat16) * 0.8)(B, Hkv, Sk, Dh)),
        "v_cache": _w((lambda *s: torch.randn(*s, dtype=torch.bfloat16) * 0.05)(B, Hkv, Sk, Dh)),
        "wq": _w((lambda *s: torch.randn(*s, dtype=torch.bfloat16) * 0.8)(D, Hq * Dh) * (D ** -0.5)),
        "wo": _w((lambda *s: torch.randn(*s, dtype=torch.bfloat16) * 0.05)(Hq * Dh, D) * ((Hq * Dh) ** -0.5)),
    }

def reference(x, k_cache, v_cache, wq, wo):
    B, Sq, D = x.shape
    Hq, Dh = 32, 128
    Hkv, Sk = k_cache.shape[1], k_cache.shape[2]
    W = min(4096, max(256, Sk // 4))
    rep = Hq // Hkv
    q = (lambda x, *d: x.permute(*d))((x @ wq).reshape(B, Sq, Hq, Dh), 0, 2, 1, 3)
    k = (lambda x, n, axis: torch.repeat_interleave(x, n, dim=axis))(k_cache[:, :, Sk - W:, :], rep, axis=1)
    v = (lambda x, n, axis: torch.repeat_interleave(x, n, dim=axis))(v_cache[:, :, Sk - W:, :], rep, axis=1)
    scores = torch.einsum("bhqd,bhkd->bhqk", q, k) * (Dh ** -0.5)
    p = _softmax(scores, axis=-1)
    o = torch.einsum("bhqk,bhkd->bhqd", p, v)
    return (lambda x, *d: x.permute(*d))(o, 0, 2, 1, 3).reshape(B, Sq, Hq * Dh) @ wo
```

```asm
; @launch grid=(256,1,1) block=(448,1,1) lds=156928
.amdgcn_target "amdgcn-amd-amdhsa--gfx950"
.text
.p2align 12
.globl standalone__sliding_block_cached__sampling_kernel
.p2align 8
.type standalone__sliding_block_cached__sampling_kernel,@function
standalone__sliding_block_cached__sampling_kernel:
    s_load_dwordx16 s[4:19], s[0:1], 0
    s_cmp_ge_u32 s2, 256
    s_cbranch_scc1 L_end
    v_lshrrev_b32 v1, 6, v0
    v_and_b32 v0, 63, v0
    v_readfirstlane_b32 s3, v1
    v_lshrrev_b32 v1, 4, v0
    v_and_b32 v2, 15, v0
    s_lshr_b32 s21, s2, 3
    v_lshlrev_b32 v3, 2, v1
    v_xor_b32 v3, v3, v2
    v_lshlrev_b32 v3, 4, v3
    s_cmp_ge_u32 s3, 4
    s_cbranch_scc1 L_svc
    s_lshl_b32 s58, s2, 19
    s_lshl_b32 s55, s3, 15
    s_add_u32 s58, s58, 393216
    s_add_u32 s58, s58, s55
    v_lshl_add_u32 v4, v1, 8, v3
    v_xor_b32 v5, 16, v4
    v_xor_b32 v6, 32, v4
    v_xor_b32 v7, 48, v4
    s_lshl_b32 s36, s3, 2
    s_lshr_b32 s36, 0x4620, s36
    s_lshr_b32 s59, s2, 4
    s_add_u32 s36, s36, s59
    s_lshr_b32 s59, s2, 7
    s_add_u32 s36, s36, s59
    s_and_b32 s36, s36, 7
    s_lshl_b32 s36, s36, 12
    s_mov_b32 m0, s55
    s_mov_b32 s26, 32768
    s_mov_b32 s27, 0x20000
    s_waitcnt lgkmcnt(0)
    s_add_u32 s24, s6, s58
    s_addc_u32 s25, s7, 0
    s_and_b32 s25, s25, 0xffff
    buffer_load_dwordx4 v4, s[24:27], s36 offen offset:0 nt lds
    buffer_load_dwordx4 v5, s[24:27], s36 offen offset:1024 nt lds
    buffer_load_dwordx4 v6, s[24:27], s36 offen offset:2048 nt lds
    buffer_load_dwordx4 v7, s[24:27], s36 offen offset:3072 nt lds
    s_add_u32 m0, s55, 4096
    s_add_u32 s36, s36, 4096
    s_and_b32 s36, s36, 32767
    buffer_load_dwordx4 v4, s[24:27], s36 offen offset:0 nt lds
    s_branch L_att
L_svc:
    s_and_b32 s22, s2, 7
    v_mov_b32 v18, 148608
    v_lshlrev_b32 v8, 4, v0
    s_cmp_eq_u32 s3, 4
    s_cbranch_scc0 L_c
    s_setprio 3
    s_lshr_b32 s53, s21, 3
    s_and_b32 s54, s21, 7
    v_lshrrev_b32 v5, 3, v0
    v_and_b32 v6, 7, v0
    v_and_b32 v7, 2, v5
    v_xor_b32 v6, v6, v7
    v_lshlrev_b32 v6, 4, v6
    v_lshl_add_u32 v5, v5, 13, v6
    v_xor_b32 v6, 64, v5
    s_lshl_b32 s23, s22, 3
    s_add_u32 s23, s23, s54
    s_lshl_b32 s24, s53, 20
    s_lshl_b32 s25, s23, 7
    s_add_u32 s24, s24, s25
    v_lshl_add_u32 v4, v1, 10, v3
    s_mov_b32 m0, 131072
    s_mov_b32 s23, 7
    s_waitcnt lgkmcnt(0)
    s_mov_b32 s32, s10
    s_and_b32 s33, s11, 0xffff
    s_mov_b32 s34, 4194304
    s_mov_b32 s35, 0x20000
    s_barrier
    v_mov_b32 v19, 1
L_wq:
    buffer_load_dwordx4 v5, s[32:35], s24 offen nt lds
    s_add_u32 m0, m0, 1024
    s_add_u32 s24, s24, 65536
    buffer_load_dwordx4 v6, s[32:35], s24 offen nt lds
    s_add_u32 m0, m0, 1024
    s_add_u32 s24, s24, 65536
    s_sub_u32 s23, s23, 1
    s_cbranch_scc0 L_wq
    s_mov_b32 s36, s4
    s_and_b32 s37, s5, 0xffff
    s_mov_b32 s38, 32768
    s_mov_b32 s39, 0x20000
    s_mov_b32 m0, 148736
    s_lshl_b32 s26, s53, 8
    s_mov_b32 s23, 0
L_x:
    v_xor_b32 v7, s23, v4
    s_add_u32 s23, s23, 16
    s_and_b32 s23, s23, 63
    buffer_load_dwordx4 v7, s[36:39], s26 offen  lds
    s_add_u32 m0, m0, 1024
    s_add_u32 s26, s26, 4096
    s_cmp_lt_u32 s26, 32768
    s_cbranch_scc1 L_x
    ds_write_b32 v18, v19 offset:60
    s_branch L_s0b
L_c:
    s_setprio 3
    s_and_b32 s36, s3, 1
    v_mov_b32 v19, 0
    v_lshl_add_u32 v4, v2, 2, v18
    ds_write_b32 v4, v19
    v_lshlrev_b32 v12, 14, v1
    v_lshl_add_u32 v12, v2, 4, v12
    s_lshl_b32 s30, s22, 16
    s_lshl_b32 s33, s21, 8
    s_add_u32 s30, s30, s33
    s_add_u32 s30, s30, 4194304
    s_lshl_b32 s33, s36, 13
    s_add_u32 s30, s30, s33
    v_mov_b32 v24, -1
    v_mov_b32 v25, -1
    v_mov_b32 v26, -1
    v_mov_b32 v27, -1
    s_mov_b32 s46, 10485760
    s_mov_b32 s47, 0x20000
    s_lshr_b32 s52, s22, 2
    s_lshl_b32 s52, s52, 21
    s_and_b32 s60, s22, 3
    s_lshl_b32 s60, s60, 14
    s_add_u32 s52, s52, s60
    s_add_u32 s52, s52, 6291456
    s_lshl_b32 s39, s21, 16
    s_add_u32 s39, s39, s52
    s_lshr_b32 s33, s2, 6
    s_lshl_b32 s33, s33, 14
    s_and_b32 s38, s2, 63
    s_lshl_b32 s38, s38, 7
    s_add_u32 s33, s33, s38
    s_add_u32 s33, s33, 4718592
    s_cmp_eq_u32 s36, 0
    s_cselect_b32 s39, s39, s33
    s_and_b32 s38, s21, 1
    s_lshl_b32 s38, s38, 13
    s_add_u32 s39, s39, s38
    s_xor_b32 s38, s39, 8192
    s_waitcnt lgkmcnt(0)
    s_load_dword s42, s[18:19], s39 glc
    s_load_dword s43, s[18:19], s38 glc
    s_load_dword s20, s[18:19], 0
    s_mov_b32 s44, s18
    s_and_b32 s45, s19, 0xffff
    buffer_store_dwordx4 v[24:27], v12, s[44:47], s30 offen sc1
    s_barrier
    s_lshl_b32 s40, s22, 8
    s_add_u32 s40, s40, 8192
    s_cmp_eq_u32 s36, 0
    s_cbranch_scc1 L_h0
    v_lshlrev_b32 v4, 7, v0
    s_cmp_eq_u32 s21, 31
    s_cbranch_scc0 L_h1
    s_mov_b64 exec, 3
    buffer_load_dword v21, v4, s[44:47], s40 offen sc1
    s_lshl_b32 s33, s22, 8
    s_add_u32 s33, s33, 12288
    buffer_load_dword v22, v4, s[44:47], s33 offen sc1
L_h1:
    s_getpc_b64 s[30:31]
L_pc:
    s_sub_u32 s30, s30, L_pc-standalone__sliding_block_cached__sampling_kernel
    s_subb_u32 s31, s31, 0
    s_lshl_b32 s33, s21, 9
    s_mov_b64 exec, 15
    v_add_u32 v4, s33, v4
    v_cmpx_gt_u32 vcc, L_codeend-standalone__sliding_block_cached__sampling_kernel, v4
    s_cbranch_execz L_h0
    global_load_dword v20, v4, s[30:31]
L_h0:
    s_mov_b64 exec, -1
    s_cmp_eq_u32 s36, 0
    s_cbranch_scc1 L_h2
    s_waitcnt vmcnt(0)
    s_waitcnt lgkmcnt(0)
    s_not_b32 s54, s43
    s_mov_b32 s43, s54
    s_load_dword s42, s[18:19], s39 glc
    s_load_dword s43, s[18:19], s38 glc
    s_waitcnt lgkmcnt(1)
    s_cmp_eq_u32 s43, s54
    s_cselect_b32 s53, 1, 0
    v_mov_b32 v19, s53
    ds_write_b32 v18, v19 offset:56
    s_branch L_c1
L_h2:
    s_getreg_b32 s33, hwreg(HW_REG_XCC_ID, 0, 4)
    s_lshl_b32 s33, s33, 28
    s_lshl_b32 s41, s21, 2
    s_add_u32 s41, s41, s40
    s_waitcnt lgkmcnt(0)
    s_not_b32 s54, s43
    s_mov_b32 s43, s54
    s_load_dword s42, s[18:19], s39 glc
    s_load_dword s43, s[18:19], s38 glc
    s_waitcnt lgkmcnt(1)
    s_cmp_eq_u32 s43, s54
    s_cselect_b32 s53, 1, 0
    s_lshl_b32 s53, s53, 27
    s_mul_i32 s62, s20, 0x9E3779B1
    s_add_u32 s62, s62, 0x7F4A7C15
    s_and_b32 s56, s62, 0x07ffffff
    s_or_b32 s56, s56, s33
    s_or_b32 s53, s53, s56
    v_mov_b32 v20, s53
    s_mov_b64 exec, 1
    buffer_store_dword v20, v8, s[44:47], s41 offen
    s_branch L_cb
L_att:
    s_and_b32 s22, s2, 7
    v_mov_b32 v18, 148608
    v_lshlrev_b32 v8, 4, v0
    s_add_u32 s28, s8, s58
    s_addc_u32 s29, s9, 0
    s_and_b32 s29, s29, 0xffff
    s_mov_b32 s30, 32768
    s_mov_b32 s31, 0x20000
    s_mov_b32 s44, s18
    s_and_b32 s45, s19, 0xffff
    s_mov_b32 s46, 10485760
    s_mov_b32 s47, 0x20000
    s_barrier
    v_and_b32 v9, 3, v2
    v_lshlrev_b32 v9, 2, v9
    v_lshrrev_b32 v3, 2, v2
    v_add_u32 v9, v9, v3
    v_xor_b32 v10, v1, v2
    v_lshlrev_b32 v10, 4, v10
    v_lshl_add_u32 v10, v9, 8, v10
    v_add_u32 v10, s55, v10
    v_xor_b32 v11, 64, v10
    v_xor_b32 v12, 0x80, v10
    v_xor_b32 v13, 0xc0, v10
    v_lshlrev_b32 v14, 8, v3
    v_lshl_add_u32 v14, v1, 4, v14
    v_add_u32 v14, 147456, v14
    v_lshlrev_b32 v15, 4, v3
    v_add_u32 v15, 148480, v15
    s_lshl_b32 s23, s3, 2
    v_add_u32 v116, s23, v15
    v_and_b32 v9, 1, v2
    v_lshlrev_b32 v9, 4, v9
    v_mov_b32 v100, 0xffff
    v_lshlrev_b32 v100, v9, v100
    v_bfe_i32 v17, v2, 1, 1
    v_not_b32 v16, v17
    v_and_b32 v16, v16, v100
    v_and_b32 v17, v17, v100
    v_lshlrev_b32 v117, 14, v1
    v_lshl_add_u32 v117, v2, 4, v117
    s_lshl_b32 s35, s22, 16
    s_lshl_b32 s33, s21, 8
    s_add_u32 s35, s35, s33
    s_add_u32 s35, s35, 4194304
    s_add_u32 s37, s35, 8192
    v_add_u32 v118, 148736, v8
    s_lshl_b32 s23, s3, 11
    v_add_u32 v119, s23, v118
    s_mov_b32 s34, 0x3e0293ee
    s_mov_b32 s39, 0
    s_mov_b32 s23, 4000000
L_s0spin:
    ds_read_b32 v19, v18 offset:60
    s_waitcnt lgkmcnt(0)
    v_readfirstlane_b32 s33, v19
    s_cmp_eq_u32 s33, 1
    s_cbranch_scc1 L_s0spin_ok
    s_sleep 1
    s_sub_u32 s23, s23, 1
    s_cbranch_scc0 L_s0spin
L_s0spin_ok:
    s_waitcnt vmcnt(4)
    buffer_load_dwordx4 v5, s[24:27], s36 offen offset:1024 nt lds
    s_waitcnt vmcnt(4)
    buffer_load_dwordx4 v6, s[24:27], s36 offen offset:2048 nt lds
    s_waitcnt vmcnt(4)
    buffer_load_dwordx4 v7, s[24:27], s36 offen offset:3072 nt lds
    s_add_u32 m0, s55, 8192
    s_add_u32 s36, s36, 4096
    s_and_b32 s36, s36, 32767
    s_waitcnt vmcnt(4)
    buffer_load_dwordx4 v4, s[24:27], s36 offen offset:0 nt lds
    s_waitcnt vmcnt(4)
    buffer_load_dwordx4 v5, s[24:27], s36 offen offset:1024 nt lds
    s_waitcnt vmcnt(4)
    buffer_load_dwordx4 v6, s[24:27], s36 offen offset:2048 nt lds
    s_waitcnt vmcnt(4)
    buffer_load_dwordx4 v7, s[24:27], s36 offen offset:3072 nt lds
    s_add_u32 m0, s55, 12288
    s_add_u32 s36, s36, 4096
    s_and_b32 s36, s36, 32767
    s_waitcnt vmcnt(4)
    buffer_load_dwordx4 v4, s[24:27], s36 offen offset:0 nt lds
    s_waitcnt vmcnt(4)
    buffer_load_dwordx4 v5, s[24:27], s36 offen offset:1024 nt lds
    s_waitcnt vmcnt(4)
    buffer_load_dwordx4 v6, s[24:27], s36 offen offset:2048 nt lds
    s_waitcnt vmcnt(4)
    buffer_load_dwordx4 v7, s[24:27], s36 offen offset:3072 nt lds
    s_mov_b64 exec, 1
    v_mov_b32 v19, 1
    ds_add_u32 v18, v19 offset:28
    s_mov_b64 exec, -1
    s_add_u32 m0, s55, 16384
    s_add_u32 s36, s36, 4096
    s_and_b32 s36, s36, 32767
    s_waitcnt vmcnt(4)
    buffer_load_dwordx4 v4, s[24:27], s36 offen offset:0 nt lds
    s_waitcnt vmcnt(4)
    buffer_load_dwordx4 v5, s[24:27], s36 offen offset:1024 nt lds
    s_waitcnt vmcnt(4)
    buffer_load_dwordx4 v6, s[24:27], s36 offen offset:2048 nt lds
    s_waitcnt vmcnt(4)
    buffer_load_dwordx4 v7, s[24:27], s36 offen offset:3072 nt lds
    s_add_u32 m0, s55, 20480
    s_add_u32 s36, s36, 4096
    s_and_b32 s36, s36, 32767
    s_waitcnt vmcnt(4)
    buffer_load_dwordx4 v4, s[24:27], s36 offen offset:0 nt lds
    s_waitcnt vmcnt(4)
    buffer_load_dwordx4 v5, s[24:27], s36 offen offset:1024 nt lds
    s_waitcnt vmcnt(4)
    buffer_load_dwordx4 v6, s[24:27], s36 offen offset:2048 nt lds
    s_waitcnt vmcnt(4)
    buffer_load_dwordx4 v7, s[24:27], s36 offen offset:3072 nt lds
    s_add_u32 m0, s55, 24576
    s_add_u32 s36, s36, 4096
    s_and_b32 s36, s36, 32767
    s_waitcnt vmcnt(4)
    buffer_load_dwordx4 v4, s[24:27], s36 offen offset:0 nt lds
    s_waitcnt vmcnt(4)
    buffer_load_dwordx4 v5, s[24:27], s36 offen offset:1024 nt lds
    s_waitcnt vmcnt(4)
    buffer_load_dwordx4 v6, s[24:27], s36 offen offset:2048 nt lds
    s_waitcnt vmcnt(4)
    buffer_load_dwordx4 v7, s[24:27], s36 offen offset:3072 nt lds
    s_add_u32 m0, s55, 28672
    s_add_u32 s36, s36, 4096
    s_and_b32 s36, s36, 32767
    s_waitcnt vmcnt(4)
    buffer_load_dwordx4 v4, s[24:27], s36 offen offset:0 nt lds
    s_waitcnt vmcnt(4)
    buffer_load_dwordx4 v5, s[24:27], s36 offen offset:1024 nt lds
    s_mov_b64 exec, 1
    v_mov_b32 v19, 1
    ds_add_u32 v18, v19 offset:48
    s_mov_b64 exec, -1
    s_waitcnt vmcnt(4)
    buffer_load_dwordx4 v6, s[24:27], s36 offen offset:2048 nt lds
    s_waitcnt vmcnt(4)
    buffer_load_dwordx4 v7, s[24:27], s36 offen offset:3072 nt lds
    s_add_u32 s36, s36, 4096
    s_and_b32 s36, s36, 32767
    s_waitcnt vmcnt(4)
    buffer_load_dwordx4 v[128:131], v8, s[28:31], s36 offen offset:0 nt
    s_waitcnt vmcnt(4)
    buffer_load_dwordx4 v[132:135], v8, s[28:31], s36 offen offset:1024 nt
    s_waitcnt vmcnt(4)
    buffer_load_dwordx4 v[136:139], v8, s[28:31], s36 offen offset:2048 nt
    ds_read_b32 v126, v18 offset:52
    s_waitcnt vmcnt(8)
    s_waitcnt lgkmcnt(0)
    v_readfirstlane_b32 s38, v126
    s_xor_b32 s38, s38, 1
    s_mov_b64 vcc, s[38:39]
    s_cbranch_vccz L_w35
    s_waitcnt vmcnt(6)
    s_cmp_eq_u32 s38, 2
    s_cbranch_scc0 L_w35
    s_waitcnt vmcnt(4)
L_w35:
    buffer_load_dwordx4 v[140:143], v8, s[28:31], s36 offen offset:3072 nt
    s_add_u32 s36, s36, 4096
    s_and_b32 s36, s36, 32767
    s_waitcnt vmcnt(8)
    s_cbranch_vccz L_w36
    s_waitcnt vmcnt(6)
    s_cmp_eq_u32 s38, 2
    s_cbranch_scc0 L_w36
    s_waitcnt vmcnt(4)
L_w36:
    buffer_load_dwordx4 v[144:147], v8, s[28:31], s36 offen offset:0 nt
    ds_read_b32 v126, v18 offset:52
    s_waitcnt vmcnt(8)
    s_waitcnt lgkmcnt(0)
    v_readfirstlane_b32 s38, v126
    s_xor_b32 s38, s38, 1
    s_mov_b64 vcc, s[38:39]
    s_cbranch_vccz L_w37
    s_waitcnt vmcnt(6)
    s_cmp_eq_u32 s38, 2
    s_cbranch_scc0 L_w37
    s_waitcnt vmcnt(4)
L_w37:
    buffer_load_dwordx4 v[148:151], v8, s[28:31], s36 offen offset:1024 nt
    s_waitcnt vmcnt(8)
    s_cbranch_vccz L_w38
    s_waitcnt vmcnt(6)
    s_cmp_eq_u32 s38, 2
    s_cbranch_scc0 L_w38
    s_waitcnt vmcnt(4)
L_w38:
    buffer_load_dwordx4 v[152:155], v8, s[28:31], s36 offen offset:2048 nt
    ds_read_b32 v126, v18 offset:52
    s_waitcnt vmcnt(8)
    s_waitcnt lgkmcnt(0)
    v_readfirstlane_b32 s38, v126
    s_xor_b32 s38, s38, 1
    s_mov_b64 vcc, s[38:39]
    s_cbranch_vccz L_w39
    s_waitcnt vmcnt(6)
    s_cmp_eq_u32 s38, 2
    s_cbranch_scc0 L_w39
    s_waitcnt vmcnt(4)
L_w39:
    buffer_load_dwordx4 v[156:159], v8, s[28:31], s36 offen offset:3072 nt
    s_add_u32 s36, s36, 4096
    s_and_b32 s36, s36, 32767
    s_waitcnt vmcnt(8)
    s_cbranch_vccz L_w40
    s_waitcnt vmcnt(6)
    s_cmp_eq_u32 s38, 2
    s_cbranch_scc0 L_w40
    s_waitcnt vmcnt(4)
L_w40:
    buffer_load_dwordx4 v[160:163], v8, s[28:31], s36 offen offset:0 nt
    s_waitcnt vmcnt(8)
    s_cbranch_vccz L_w41
    s_waitcnt vmcnt(6)
    s_cmp_eq_u32 s38, 2
    s_cbranch_scc0 L_w41
    s_waitcnt vmcnt(4)
L_w41:
    buffer_load_dwordx4 v[164:167], v8, s[28:31], s36 offen offset:1024 nt
    s_mov_b32 s23, 4000000
L_qspin:
    ds_read_b32 v19, v18 offset:0
    s_waitcnt lgkmcnt(0)
    v_readfirstlane_b32 s33, v19
    s_cmp_eq_u32 s33, 1
    s_cbranch_scc1 L_qspin_ok
    s_sleep 1
    s_sub_u32 s23, s23, 1
    s_cbranch_scc0 L_qspin
L_qspin_ok:
    ds_read_b128 v[20:23], v14 offset:0
    ds_read_b128 v[24:27], v14 offset:64
    ds_read_b128 v[28:31], v14 offset:128
    ds_read_b128 v[32:35], v14 offset:192
    ds_read_b128 v[36:39], v10 offset:0
    ds_read_b128 v[40:43], v11 offset:0
    ds_read_b128 v[44:47], v12 offset:0
    ds_read_b128 v[48:51], v13 offset:0
    ds_read_b128 v[52:55], v10 offset:4096
    ds_read_b128 v[56:59], v11 offset:4096
    ds_read_b128 v[60:63], v12 offset:4096
    ds_read_b128 v[64:67], v13 offset:4096
    s_waitcnt lgkmcnt(4)
    v_mfma_f32_16x16x32_bf16 v[68:71], v[36:39], v[20:23], 0
    v_mfma_f32_16x16x32_bf16 v[68:71], v[40:43], v[24:27], v[68:71]
    v_mfma_f32_16x16x32_bf16 v[68:71], v[44:47], v[28:31], v[68:71]
    v_mfma_f32_16x16x32_bf16 v[68:71], v[48:51], v[32:35], v[68:71]
    ds_read_b128 v[36:39], v10 offset:8192
    ds_read_b128 v[40:43], v11 offset:8192
    ds_read_b128 v[44:47], v12 offset:8192
    ds_read_b128 v[48:51], v13 offset:8192
    s_waitcnt lgkmcnt(4)
    v_mfma_f32_16x16x32_bf16 v[72:75], v[52:55], v[20:23], 0
    v_mfma_f32_16x16x32_bf16 v[72:75], v[56:59], v[24:27], v[72:75]
    v_mfma_f32_16x16x32_bf16 v[72:75], v[60:63], v[28:31], v[72:75]
    v_mfma_f32_16x16x32_bf16 v[72:75], v[64:67], v[32:35], v[72:75]
    ds_read_b128 v[52:55], v10 offset:12288
    ds_read_b128 v[56:59], v11 offset:12288
    ds_read_b128 v[60:63], v12 offset:12288
    ds_read_b128 v[64:67], v13 offset:12288
    s_waitcnt vmcnt(8)
    s_cbranch_vccz L_w42
    s_waitcnt vmcnt(6)
    s_cmp_eq_u32 s38, 2
    s_cbranch_scc0 L_w42
    s_waitcnt vmcnt(4)
L_w42:
    buffer_load_dwordx4 v[168:171], v8, s[28:31], s36 offen offset:2048 nt
    s_waitcnt lgkmcnt(4)
    v_mfma_f32_16x16x32_bf16 v[76:79], v[36:39], v[20:23], 0
    v_mfma_f32_16x16x32_bf16 v[76:79], v[40:43], v[24:27], v[76:79]
    v_mfma_f32_16x16x32_bf16 v[76:79], v[44:47], v[28:31], v[76:79]
    v_mfma_f32_16x16x32_bf16 v[76:79], v[48:51], v[32:35], v[76:79]
    ds_read_b128 v[36:39], v10 offset:16384
    ds_read_b128 v[40:43], v11 offset:16384
    ds_read_b128 v[44:47], v12 offset:16384
    ds_read_b128 v[48:51], v13 offset:16384
    s_waitcnt lgkmcnt(4)
    v_mfma_f32_16x16x32_bf16 v[80:83], v[52:55], v[20:23], 0
    v_mfma_f32_16x16x32_bf16 v[80:83], v[56:59], v[24:27], v[80:83]
    v_mfma_f32_16x16x32_bf16 v[80:83], v[60:63], v[28:31], v[80:83]
    v_mfma_f32_16x16x32_bf16 v[80:83], v[64:67], v[32:35], v[80:83]
    ds_read_b128 v[52:55], v10 offset:20480
    ds_read_b128 v[56:59], v11 offset:20480
    ds_read_b128 v[60:63], v12 offset:20480
    ds_read_b128 v[64:67], v13 offset:20480
    s_waitcnt vmcnt(8)
    s_cbranch_vccz L_w43
    s_waitcnt vmcnt(6)
    s_cmp_eq_u32 s38, 2
    s_cbranch_scc0 L_w43
    s_waitcnt vmcnt(4)
L_w43:
    buffer_load_dwordx4 v[172:175], v8, s[28:31], s36 offen offset:3072 nt
    s_waitcnt lgkmcnt(4)
    v_mfma_f32_16x16x32_bf16 v[84:87], v[36:39], v[20:23], 0
    v_mfma_f32_16x16x32_bf16 v[84:87], v[40:43], v[24:27], v[84:87]
    v_mfma_f32_16x16x32_bf16 v[84:87], v[44:47], v[28:31], v[84:87]
    v_mfma_f32_16x16x32_bf16 v[84:87], v[48:51], v[32:35], v[84:87]
    ds_read_b128 v[36:39], v10 offset:24576
    ds_read_b128 v[40:43], v11 offset:24576
    ds_read_b128 v[44:47], v12 offset:24576
    ds_read_b128 v[48:51], v13 offset:24576
    s_waitcnt lgkmcnt(4)
    v_mfma_f32_16x16x32_bf16 v[88:91], v[52:55], v[20:23], 0
    v_mfma_f32_16x16x32_bf16 v[88:91], v[56:59], v[24:27], v[88:91]
    v_mfma_f32_16x16x32_bf16 v[88:91], v[60:63], v[28:31], v[88:91]
    v_mfma_f32_16x16x32_bf16 v[88:91], v[64:67], v[32:35], v[88:91]
    ds_read_b128 v[52:55], v10 offset:28672
    ds_read_b128 v[56:59], v11 offset:28672
    ds_read_b128 v[60:63], v12 offset:28672
    ds_read_b128 v[64:67], v13 offset:28672
    s_add_u32 s36, s36, 4096
    s_and_b32 s36, s36, 32767
    s_waitcnt vmcnt(8)
    s_cbranch_vccz L_w44
    s_waitcnt vmcnt(6)
    s_cmp_eq_u32 s38, 2
    s_cbranch_scc0 L_w44
    s_waitcnt vmcnt(4)
L_w44:
    buffer_load_dwordx4 v[176:179], v8, s[28:31], s36 offen offset:0 nt
    s_waitcnt lgkmcnt(4)
    v_mfma_f32_16x16x32_bf16 v[92:95], v[36:39], v[20:23], 0
    v_mfma_f32_16x16x32_bf16 v[92:95], v[40:43], v[24:27], v[92:95]
    v_mfma_f32_16x16x32_bf16 v[92:95], v[44:47], v[28:31], v[92:95]
    v_mfma_f32_16x16x32_bf16 v[92:95], v[48:51], v[32:35], v[92:95]
    s_waitcnt lgkmcnt(0)
    v_mfma_f32_16x16x32_bf16 v[96:99], v[52:55], v[20:23], 0
    v_mfma_f32_16x16x32_bf16 v[96:99], v[56:59], v[24:27], v[96:99]
    v_mfma_f32_16x16x32_bf16 v[96:99], v[60:63], v[28:31], v[96:99]
    v_mfma_f32_16x16x32_bf16 v[96:99], v[64:67], v[32:35], v[96:99]
    s_waitcnt vmcnt(8)
    s_cbranch_vccz L_w45
    s_waitcnt vmcnt(6)
    s_cmp_eq_u32 s38, 2
    s_cbranch_scc0 L_w45
    s_waitcnt vmcnt(4)
L_w45:
    buffer_load_dwordx4 v[180:183], v8, s[28:31], s36 offen offset:1024 nt
    s_nop 3
    v_max3_f32 v100, v68, v69, v70
    v_max3_f32 v101, v71, v72, v73
    v_max3_f32 v100, v100, v74, v75
    v_max3_f32 v101, v101, v76, v77
    v_max3_f32 v100, v100, v78, v79
    v_max3_f32 v101, v101, v80, v81
    v_max3_f32 v100, v100, v82, v83
    v_max3_f32 v101, v101, v84, v85
    v_max3_f32 v100, v100, v86, v87
    v_max3_f32 v101, v101, v88, v89
    v_max3_f32 v100, v100, v90, v91
    v_max3_f32 v101, v101, v92, v93
    v_max3_f32 v100, v100, v94, v95
    v_max3_f32 v101, v101, v96, v97
    v_max3_f32 v100, v100, v98, v99
    v_max_f32 v100, v100, v101
    v_mov_b32 v101, v100
    s_nop 1
    v_permlane32_swap_b32 v100, v101
    s_nop 1
    v_max_f32 v100, v100, v101
    v_mov_b32 v101, v100
    s_nop 1
    v_permlane16_swap_b32 v100, v101
    s_nop 1
    v_max_f32 v100, v100, v101
    v_mul_f32 v100, s34, v100
    v_fma_f32 v68, v68, s34, -v100
    v_fma_f32 v69, v69, s34, -v100
    v_fma_f32 v70, v70, s34, -v100
    v_fma_f32 v71, v71, s34, -v100
    v_fma_f32 v72, v72, s34, -v100
    v_fma_f32 v73, v73, s34, -v100
    v_fma_f32 v74, v74, s34, -v100
    v_fma_f32 v75, v75, s34, -v100
    v_fma_f32 v76, v76, s34, -v100
    v_fma_f32 v77, v77, s34, -v100
    v_fma_f32 v78, v78, s34, -v100
    v_fma_f32 v79, v79, s34, -v100
    v_fma_f32 v80, v80, s34, -v100
    v_fma_f32 v81, v81, s34, -v100
    v_fma_f32 v82, v82, s34, -v100
    v_fma_f32 v83, v83, s34, -v100
    v_fma_f32 v84, v84, s34, -v100
    v_fma_f32 v85, v85, s34, -v100
    v_fma_f32 v86, v86, s34, -v100
    v_fma_f32 v87, v87, s34, -v100
    v_fma_f32 v88, v88, s34, -v100
    v_fma_f32 v89, v89, s34, -v100
    v_fma_f32 v90, v90, s34, -v100
    v_fma_f32 v91, v91, s34, -v100
    v_fma_f32 v92, v92, s34, -v100
    v_fma_f32 v93, v93, s34, -v100
    v_fma_f32 v94, v94, s34, -v100
    v_fma_f32 v95, v95, s34, -v100
    v_fma_f32 v96, v96, s34, -v100
    v_fma_f32 v97, v97, s34, -v100
    v_fma_f32 v98, v98, s34, -v100
    v_fma_f32 v99, v99, s34, -v100
    s_waitcnt vmcnt(8)
    s_cbranch_vccz L_w46
    s_waitcnt vmcnt(6)
    s_cmp_eq_u32 s38, 2
    s_cbranch_scc0 L_w46
    s_waitcnt vmcnt(4)
L_w46:
    buffer_load_dwordx4 v[184:187], v8, s[28:31], s36 offen offset:2048 nt
    v_exp_f32 v68, v68
    v_exp_f32 v69, v69
    v_exp_f32 v70, v70
    v_exp_f32 v71, v71
    v_exp_f32 v72, v72
    v_exp_f32 v73, v73
    v_exp_f32 v74, v74
    v_exp_f32 v75, v75
    v_exp_f32 v76, v76
    v_exp_f32 v77, v77
    v_exp_f32 v78, v78
    v_exp_f32 v79, v79
    v_exp_f32 v80, v80
    v_exp_f32 v81, v81
    v_exp_f32 v82, v82
    v_exp_f32 v83, v83
    v_exp_f32 v84, v84
    v_exp_f32 v85, v85
    v_exp_f32 v86, v86
    v_exp_f32 v87, v87
    v_exp_f32 v88, v88
    v_exp_f32 v89, v89
    v_exp_f32 v90, v90
    v_exp_f32 v91, v91
    v_exp_f32 v92, v92
    v_exp_f32 v93, v93
    v_exp_f32 v94, v94
    v_exp_f32 v95, v95
    v_exp_f32 v96, v96
    v_exp_f32 v97, v97
    v_exp_f32 v98, v98
    v_exp_f32 v99, v99
    s_waitcnt vmcnt(8)
    s_cbranch_vccz L_w47
    s_waitcnt vmcnt(6)
    s_cmp_eq_u32 s38, 2
    s_cbranch_scc0 L_w47
    s_waitcnt vmcnt(4)
L_w47:
    buffer_load_dwordx4 v[188:191], v8, s[28:31], s36 offen offset:3072 nt
    v_pk_add_f32 v[102:103], v[68:69], v[70:71]
    v_pk_add_f32 v[102:103], v[102:103], v[72:73]
    v_pk_add_f32 v[102:103], v[102:103], v[74:75]
    v_pk_add_f32 v[102:103], v[102:103], v[76:77]
    v_pk_add_f32 v[102:103], v[102:103], v[78:79]
    v_pk_add_f32 v[102:103], v[102:103], v[80:81]
    v_pk_add_f32 v[102:103], v[102:103], v[82:83]
    v_pk_add_f32 v[102:103], v[102:103], v[84:85]
    v_pk_add_f32 v[102:103], v[102:103], v[86:87]
    v_pk_add_f32 v[102:103], v[102:103], v[88:89]
    v_pk_add_f32 v[102:103], v[102:103], v[90:91]
    v_pk_add_f32 v[102:103], v[102:103], v[92:93]
    v_pk_add_f32 v[102:103], v[102:103], v[94:95]
    v_pk_add_f32 v[102:103], v[102:103], v[96:97]
    v_pk_add_f32 v[102:103], v[102:103], v[98:99]
    v_add_f32 v102, v102, v103
    v_mov_b32 v101, v102
    s_nop 1
    v_permlane32_swap_b32 v102, v101
    s_nop 1
    v_add_f32 v102, v102, v101
    v_mov_b32 v101, v102
    s_nop 1
    v_permlane16_swap_b32 v102, v101
    s_nop 1
    v_add_f32 v102, v102, v101
    ds_write_b32 v116, v100
    ds_write_b32 v116, v102 offset:64
    s_mov_b64 exec, 1
    v_mov_b32 v19, 1
    ds_add_u32 v18, v19 offset:4
    s_mov_b64 exec, -1
    s_add_u32 s36, s36, 4096
    s_and_b32 s36, s36, 32767
    s_waitcnt vmcnt(8)
    s_cbranch_vccz L_w48
    s_waitcnt vmcnt(6)
    s_cmp_eq_u32 s38, 2
    s_cbranch_scc0 L_w48
    s_waitcnt vmcnt(4)
L_w48:
    buffer_load_dwordx4 v[192:195], v8, s[28:31], s36 offen offset:0 nt
    s_waitcnt vmcnt(8)
    s_cbranch_vccz L_w49
    s_waitcnt vmcnt(6)
    s_cmp_eq_u32 s38, 2
    s_cbranch_scc0 L_w49
    s_waitcnt vmcnt(4)
L_w49:
    buffer_load_dwordx4 v[196:199], v8, s[28:31], s36 offen offset:1024 nt
    s_mov_b32 s23, 4000000
L_sspin:
    ds_read_b32 v19, v18 offset:4
    s_waitcnt lgkmcnt(0)
    v_readfirstlane_b32 s33, v19
    s_cmp_eq_u32 s33, 4
    s_cbranch_scc1 L_sspin_ok
    s_sleep 1
    s_sub_u32 s23, s23, 1
    s_cbranch_scc0 L_sspin
L_sspin_ok:
    ds_read_b128 v[104:107], v15
    ds_read_b128 v[120:123], v15 offset:64
    s_waitcnt lgkmcnt(0)
    v_max3_f32 v101, v104, v105, v106
    v_max_f32 v101, v101, v107
    v_sub_f32 v104, v104, v101
    v_sub_f32 v105, v105, v101
    v_sub_f32 v106, v106, v101
    v_sub_f32 v107, v107, v101
    v_sub_f32 v100, v100, v101
    v_exp_f32 v104, v104
    v_exp_f32 v105, v105
    v_exp_f32 v106, v106
    v_exp_f32 v107, v107
    v_exp_f32 v100, v100
    v_mul_f32 v102, v104, v120
    v_fmac_f32 v102, v105, v121
    v_fmac_f32 v102, v106, v122
    v_fmac_f32 v102, v107, v123
    v_rcp_f32 v102, v102
    s_nop 0
    v_mul_f32 v100, v100, v102
    v_mul_f32 v101, v100, v68
    v_cvt_pk_bf16_f32 v101, v101, v101
    v_and_b32 v20, v101, v16
    v_and_b32 v21, v101, v17
    s_waitcnt vmcnt(8)
    s_cbranch_vccz L_w50
    s_waitcnt vmcnt(6)
    s_cmp_eq_u32 s38, 2
    s_cbranch_scc0 L_w50
    s_waitcnt vmcnt(4)
L_w50:
    buffer_load_dwordx4 v[200:203], v8, s[28:31], s36 offen offset:2048 nt
    v_mul_f32 v101, v100, v69
    v_cvt_pk_bf16_f32 v101, v101, v101
    v_and_b32 v22, v101, v16
    v_and_b32 v23, v101, v17
    v_mul_f32 v101, v100, v70
    v_cvt_pk_bf16_f32 v101, v101, v101
    v_and_b32 v24, v101, v16
    v_and_b32 v25, v101, v17
    v_mul_f32 v101, v100, v71
    v_cvt_pk_bf16_f32 v101, v101, v101
    v_and_b32 v26, v101, v16
    v_and_b32 v27, v101, v17
    v_mul_f32 v101, v100, v72
    v_cvt_pk_bf16_f32 v101, v101, v101
    v_and_b32 v28, v101, v16
    v_and_b32 v29, v101, v17
    v_mul_f32 v101, v100, v73
    v_cvt_pk_bf16_f32 v101, v101, v101
    v_and_b32 v30, v101, v16
    v_and_b32 v31, v101, v17
    v_mul_f32 v101, v100, v74
    v_cvt_pk_bf16_f32 v101, v101, v101
    v_and_b32 v32, v101, v16
    v_and_b32 v33, v101, v17
    v_mul_f32 v101, v100, v75
    v_cvt_pk_bf16_f32 v101, v101, v101
    v_and_b32 v34, v101, v16
    v_and_b32 v35, v101, v17
    v_mul_f32 v101, v100, v76
    v_cvt_pk_bf16_f32 v101, v101, v101
    v_and_b32 v36, v101, v16
    v_and_b32 v37, v101, v17
    v_mul_f32 v101, v100, v77
    v_cvt_pk_bf16_f32 v101, v101, v101
    v_and_b32 v38, v101, v16
    v_and_b32 v39, v101, v17
    s_waitcnt vmcnt(8)
    s_cbranch_vccz L_w51
    s_waitcnt vmcnt(6)
    s_cmp_eq_u32 s38, 2
    s_cbranch_scc0 L_w51
    s_waitcnt vmcnt(4)
L_w51:
    buffer_load_dwordx4 v[204:207], v8, s[28:31], s36 offen offset:3072 nt
    v_mul_f32 v101, v100, v78
    v_cvt_pk_bf16_f32 v101, v101, v101
    v_and_b32 v40, v101, v16
    v_and_b32 v41, v101, v17
    v_mul_f32 v101, v100, v79
    v_cvt_pk_bf16_f32 v101, v101, v101
    v_and_b32 v42, v101, v16
    v_and_b32 v43, v101, v17
    v_mul_f32 v101, v100, v80
    v_cvt_pk_bf16_f32 v101, v101, v101
    v_and_b32 v44, v101, v16
    v_and_b32 v45, v101, v17
    v_mul_f32 v101, v100, v81
    v_cvt_pk_bf16_f32 v101, v101, v101
    v_and_b32 v46, v101, v16
    v_and_b32 v47, v101, v17
    v_mul_f32 v101, v100, v82
    v_cvt_pk_bf16_f32 v101, v101, v101
    v_and_b32 v48, v101, v16
    v_and_b32 v49, v101, v17
    v_mul_f32 v101, v100, v83
    v_cvt_pk_bf16_f32 v101, v101, v101
    v_and_b32 v50, v101, v16
    v_and_b32 v51, v101, v17
    v_mul_f32 v101, v100, v84
    v_cvt_pk_bf16_f32 v101, v101, v101
    v_and_b32 v52, v101, v16
    v_and_b32 v53, v101, v17
    v_mul_f32 v101, v100, v85
    v_cvt_pk_bf16_f32 v101, v101, v101
    v_and_b32 v54, v101, v16
    v_and_b32 v55, v101, v17
    v_mul_f32 v101, v100, v86
    v_cvt_pk_bf16_f32 v101, v101, v101
    v_and_b32 v56, v101, v16
    v_and_b32 v57, v101, v17
    s_add_u32 s36, s36, 4096
    s_and_b32 s36, s36, 32767
    s_waitcnt vmcnt(8)
    s_cbranch_vccz L_w52
    s_waitcnt vmcnt(6)
    s_cmp_eq_u32 s38, 2
    s_cbranch_scc0 L_w52
    s_waitcnt vmcnt(4)
L_w52:
    buffer_load_dwordx4 v[208:211], v8, s[28:31], s36 offen offset:0 nt
    v_mul_f32 v101, v100, v87
    v_cvt_pk_bf16_f32 v101, v101, v101
    v_and_b32 v58, v101, v16
    v_and_b32 v59, v101, v17
    v_mul_f32 v101, v100, v88
    v_cvt_pk_bf16_f32 v101, v101, v101
    v_and_b32 v60, v101, v16
    v_and_b32 v61, v101, v17
    v_mul_f32 v101, v100, v89
    v_cvt_pk_bf16_f32 v101, v101, v101
    v_and_b32 v62, v101, v16
    v_and_b32 v63, v101, v17
    v_mul_f32 v101, v100, v90
    v_cvt_pk_bf16_f32 v101, v101, v101
    v_and_b32 v64, v101, v16
    v_and_b32 v65, v101, v17
    v_mul_f32 v101, v100, v91
    v_cvt_pk_bf16_f32 v101, v101, v101
    v_and_b32 v66, v101, v16
    v_and_b32 v67, v101, v17
    v_mul_f32 v101, v100, v92
    v_cvt_pk_bf16_f32 v101, v101, v101
    v_and_b32 v68, v101, v16
    v_and_b32 v69, v101, v17
    v_mul_f32 v101, v100, v93
    v_cvt_pk_bf16_f32 v101, v101, v101
    v_and_b32 v70, v101, v16
    v_and_b32 v71, v101, v17
    v_mul_f32 v101, v100, v94
    v_cvt_pk_bf16_f32 v101, v101, v101
    v_and_b32 v72, v101, v16
    v_and_b32 v73, v101, v17
    v_mul_f32 v101, v100, v95
    v_cvt_pk_bf16_f32 v101, v101, v101
    v_and_b32 v74, v101, v16
    v_and_b32 v75, v101, v17
    s_waitcnt vmcnt(8)
    s_cbranch_vccz L_w53
    s_waitcnt vmcnt(6)
    s_cmp_eq_u32 s38, 2
    s_cbranch_scc0 L_w53
    s_waitcnt vmcnt(4)
L_w53:
    buffer_load_dwordx4 v[212:215], v8, s[28:31], s36 offen offset:1024 nt
    v_mul_f32 v101, v100, v96
    v_cvt_pk_bf16_f32 v101, v101, v101
    v_and_b32 v76, v101, v16
    v_and_b32 v77, v101, v17
    v_mul_f32 v101, v100, v97
    v_cvt_pk_bf16_f32 v101, v101, v101
    v_and_b32 v78, v101, v16
    v_and_b32 v79, v101, v17
    v_mul_f32 v101, v100, v98
    v_cvt_pk_bf16_f32 v101, v101, v101
    v_and_b32 v80, v101, v16
    v_and_b32 v81, v101, v17
    v_mul_f32 v101, v100, v99
    v_cvt_pk_bf16_f32 v101, v101, v101
    v_and_b32 v82, v101, v16
    v_and_b32 v83, v101, v17
    s_cmp_eq_u32 s3, 3
    s_cbranch_scc1 L_last
    s_waitcnt vmcnt(6)
    buffer_load_dwordx4 v[216:219], v8, s[28:31], s36 offen offset:2048 nt
    v_mfma_f32_16x16x16_bf16 v[108:111], v[20:21], v[128:129], 0
    v_mfma_f32_16x16x16_bf16 v[112:115], v[20:21], v[130:131], 0
    v_mfma_f32_16x16x16_bf16 v[108:111], v[22:23], v[132:133], v[108:111]
    v_mfma_f32_16x16x16_bf16 v[112:115], v[22:23], v[134:135], v[112:115]
    v_mfma_f32_16x16x16_bf16 v[108:111], v[24:25], v[136:137], v[108:111]
    v_mfma_f32_16x16x16_bf16 v[112:115], v[24:25], v[138:139], v[112:115]
    v_mfma_f32_16x16x16_bf16 v[108:111], v[26:27], v[140:141], v[108:111]
    v_mfma_f32_16x16x16_bf16 v[112:115], v[26:27], v[142:143], v[112:115]
    v_mfma_f32_16x16x16_bf16 v[108:111], v[28:29], v[144:145], v[108:111]
    v_mfma_f32_16x16x16_bf16 v[112:115], v[28:29], v[146:147], v[112:115]
    v_mfma_f32_16x16x16_bf16 v[108:111], v[30:31], v[148:149], v[108:111]
    v_mfma_f32_16x16x16_bf16 v[112:115], v[30:31], v[150:151], v[112:115]
    s_waitcnt vmcnt(6)
    buffer_load_dwordx4 v[220:223], v8, s[28:31], s36 offen offset:3072 nt
    v_mfma_f32_16x16x16_bf16 v[108:111], v[32:33], v[152:153], v[108:111]
    v_mfma_f32_16x16x16_bf16 v[112:115], v[32:33], v[154:155], v[112:115]
    v_mfma_f32_16x16x16_bf16 v[108:111], v[34:35], v[156:157], v[108:111]
    v_mfma_f32_16x16x16_bf16 v[112:115], v[34:35], v[158:159], v[112:115]
    v_mfma_f32_16x16x16_bf16 v[108:111], v[36:37], v[160:161], v[108:111]
    v_mfma_f32_16x16x16_bf16 v[112:115], v[36:37], v[162:163], v[112:115]
    v_mfma_f32_16x16x16_bf16 v[108:111], v[38:39], v[164:165], v[108:111]
    v_mfma_f32_16x16x16_bf16 v[112:115], v[38:39], v[166:167], v[112:115]
    v_mfma_f32_16x16x16_bf16 v[108:111], v[40:41], v[168:169], v[108:111]
    v_mfma_f32_16x16x16_bf16 v[112:115], v[40:41], v[170:171], v[112:115]
    v_mfma_f32_16x16x16_bf16 v[108:111], v[42:43], v[172:173], v[108:111]
    v_mfma_f32_16x16x16_bf16 v[112:115], v[42:43], v[174:175], v[112:115]
    s_add_u32 s36, s36, 4096
    s_and_b32 s36, s36, 32767
    s_waitcnt vmcnt(6)
    buffer_load_dwordx4 v[224:227], v8, s[28:31], s36 offen offset:0 nt
    v_mfma_f32_16x16x16_bf16 v[108:111], v[44:45], v[176:177], v[108:111]
    v_mfma_f32_16x16x16_bf16 v[112:115], v[44:45], v[178:179], v[112:115]
    v_mfma_f32_16x16x16_bf16 v[108:111], v[46:47], v[180:181], v[108:111]
    v_mfma_f32_16x16x16_bf16 v[112:115], v[46:47], v[182:183], v[112:115]
    v_mfma_f32_16x16x16_bf16 v[108:111], v[48:49], v[184:185], v[108:111]
    v_mfma_f32_16x16x16_bf16 v[112:115], v[48:49], v[186:187], v[112:115]
    v_mfma_f32_16x16x16_bf16 v[108:111], v[50:51], v[188:189], v[108:111]
    v_mfma_f32_16x16x16_bf16 v[112:115], v[50:51], v[190:191], v[112:115]
    v_mfma_f32_16x16x16_bf16 v[108:111], v[52:53], v[192:193], v[108:111]
    v_mfma_f32_16x16x16_bf16 v[112:115], v[52:53], v[194:195], v[112:115]
    v_mfma_f32_16x16x16_bf16 v[108:111], v[54:55], v[196:197], v[108:111]
    v_mfma_f32_16x16x16_bf16 v[112:115], v[54:55], v[198:199], v[112:115]
    s_waitcnt vmcnt(6)
    buffer_load_dwordx4 v[228:231], v8, s[28:31], s36 offen offset:1024 nt
    v_mfma_f32_16x16x16_bf16 v[108:111], v[56:57], v[200:201], v[108:111]
    v_mfma_f32_16x16x16_bf16 v[112:115], v[56:57], v[202:203], v[112:115]
    s_waitcnt vmcnt(6)
    buffer_load_dwordx4 v[232:235], v8, s[28:31], s36 offen offset:2048 nt
    v_mfma_f32_16x16x16_bf16 v[108:111], v[58:59], v[204:205], v[108:111]
    v_mfma_f32_16x16x16_bf16 v[112:115], v[58:59], v[206:207], v[112:115]
    s_waitcnt vmcnt(6)
    buffer_load_dwordx4 v[236:239], v8, s[28:31], s36 offen offset:3072 nt
    v_mfma_f32_16x16x16_bf16 v[108:111], v[60:61], v[208:209], v[108:111]
    v_mfma_f32_16x16x16_bf16 v[112:115], v[60:61], v[210:211], v[112:115]
    s_add_u32 s36, s36, 4096
    s_and_b32 s36, s36, 32767
    s_waitcnt vmcnt(6)
    buffer_load_dwordx4 v[240:243], v8, s[28:31], s36 offen offset:0 nt
    v_mfma_f32_16x16x16_bf16 v[108:111], v[62:63], v[212:213], v[108:111]
    v_mfma_f32_16x16x16_bf16 v[112:115], v[62:63], v[214:215], v[112:115]
    s_waitcnt vmcnt(6)
    buffer_load_dwordx4 v[244:247], v8, s[28:31], s36 offen offset:1024 nt
    v_mfma_f32_16x16x16_bf16 v[108:111], v[64:65], v[216:217], v[108:111]
    v_mfma_f32_16x16x16_bf16 v[112:115], v[64:65], v[218:219], v[112:115]
    s_waitcnt vmcnt(6)
    buffer_load_dwordx4 v[248:251], v8, s[28:31], s36 offen offset:2048 nt
    v_mfma_f32_16x16x16_bf16 v[108:111], v[66:67], v[220:221], v[108:111]
    v_mfma_f32_16x16x16_bf16 v[112:115], v[66:67], v[222:223], v[112:115]
    s_waitcnt vmcnt(6)
    buffer_load_dwordx4 v[252:255], v8, s[28:31], s36 offen offset:3072 nt
    v_mfma_f32_16x16x16_bf16 v[108:111], v[68:69], v[224:225], v[108:111]
    v_mfma_f32_16x16x16_bf16 v[112:115], v[68:69], v[226:227], v[112:115]
    s_mov_b64 exec, 1
    v_mov_b32 v19, 1
    ds_add_u32 v18, v19 offset:8
    s_mov_b64 exec, -1
    s_mov_b32 s40, s12
    s_and_b32 s41, s13, 0xffff
    s_mov_b32 s42, 4194304
    s_mov_b32 s43, 0x20000
    v_lshrrev_b32 v5, 3, v0
    v_and_b32 v6, 7, v0
    v_and_b32 v7, 2, v5
    v_xor_b32 v6, v6, v7
    v_lshlrev_b32 v6, 4, v6
    v_lshl_add_u32 v5, v5, 10, v6
    v_xor_b32 v6, 64, v5
    s_lshl_b32 s24, s21, 17
    s_lshl_b32 s25, s22, 7
    s_add_u32 s24, s24, s25
    s_lshl_b32 s25, s3, 15
    s_add_u32 s24, s24, s25
    s_lshl_b32 s25, s3, 12
    s_add_u32 m0, s25, 131072
    s_add_u32 s52, s24, 7168
    s_add_u32 s53, s24, 14336
    s_add_u32 s54, s24, 21504
    s_waitcnt vmcnt(6)
    v_mfma_f32_16x16x16_bf16 v[108:111], v[70:71], v[228:229], v[108:111]
    v_mfma_f32_16x16x16_bf16 v[112:115], v[70:71], v[230:231], v[112:115]
    s_waitcnt vmcnt(5)
    v_mfma_f32_16x16x16_bf16 v[108:111], v[72:73], v[232:233], v[108:111]
    v_mfma_f32_16x16x16_bf16 v[112:115], v[72:73], v[234:235], v[112:115]
    s_waitcnt vmcnt(4)
    v_mfma_f32_16x16x16_bf16 v[108:111], v[74:75], v[236:237], v[108:111]
    v_mfma_f32_16x16x16_bf16 v[112:115], v[74:75], v[238:239], v[112:115]
    s_waitcnt vmcnt(3)
    v_mfma_f32_16x16x16_bf16 v[108:111], v[76:77], v[240:241], v[108:111]
    v_mfma_f32_16x16x16_bf16 v[112:115], v[76:77], v[242:243], v[112:115]
    s_waitcnt vmcnt(2)
    v_mfma_f32_16x16x16_bf16 v[108:111], v[78:79], v[244:245], v[108:111]
    v_mfma_f32_16x16x16_bf16 v[112:115], v[78:79], v[246:247], v[112:115]
    s_waitcnt vmcnt(1)
    v_mfma_f32_16x16x16_bf16 v[108:111], v[80:81], v[248:249], v[108:111]
    v_mfma_f32_16x16x16_bf16 v[112:115], v[80:81], v[250:251], v[112:115]
    s_waitcnt vmcnt(0)
    v_mfma_f32_16x16x16_bf16 v[108:111], v[82:83], v[252:253], v[108:111]
    v_mfma_f32_16x16x16_bf16 v[112:115], v[82:83], v[254:255], v[112:115]
    v_mov_b32 v19, 1
    s_nop 6
    ds_write_b128 v119, v[108:111]
    ds_write_b128 v119, v[112:115] offset:1024
    s_mov_b64 exec, 1
    ds_add_u32 v18, v19 offset:12
    s_mov_b64 exec, -1
    buffer_load_dwordx4 v5, s[40:43], s24 offen offset:0 nt lds
    buffer_load_dwordx4 v6, s[40:43], s52 offen offset:1024 nt lds
    buffer_load_dwordx4 v5, s[40:43], s53 offen offset:2048 nt lds
    buffer_load_dwordx4 v6, s[40:43], s54 offen offset:3072 nt lds
    s_cmp_eq_u32 s3, 2
    s_cbranch_scc0 L_red
    s_add_u32 m0, m0, 4096
    s_add_u32 s24, s24, 32768
    s_add_u32 s52, s52, 32768
    s_add_u32 s53, s53, 32768
    s_add_u32 s54, s54, 32768
    buffer_load_dwordx4 v5, s[40:43], s24 offen offset:0 nt lds
    buffer_load_dwordx4 v6, s[40:43], s52 offen offset:1024 nt lds
    buffer_load_dwordx4 v5, s[40:43], s53 offen offset:2048 nt lds
    buffer_load_dwordx4 v6, s[40:43], s54 offen offset:3072 nt lds
    s_branch L_red
L_last:
    v_mfma_f32_16x16x16_bf16 v[108:111], v[20:21], v[128:129], 0
    v_mfma_f32_16x16x16_bf16 v[112:115], v[20:21], v[130:131], 0
    v_mfma_f32_16x16x16_bf16 v[108:111], v[22:23], v[132:133], v[108:111]
    v_mfma_f32_16x16x16_bf16 v[112:115], v[22:23], v[134:135], v[112:115]
    v_mfma_f32_16x16x16_bf16 v[108:111], v[24:25], v[136:137], v[108:111]
    v_mfma_f32_16x16x16_bf16 v[112:115], v[24:25], v[138:139], v[112:115]
    v_mfma_f32_16x16x16_bf16 v[108:111], v[26:27], v[140:141], v[108:111]
    v_mfma_f32_16x16x16_bf16 v[112:115], v[26:27], v[142:143], v[112:115]
    v_mfma_f32_16x16x16_bf16 v[108:111], v[28:29], v[144:145], v[108:111]
    v_mfma_f32_16x16x16_bf16 v[112:115], v[28:29], v[146:147], v[112:115]
    v_mfma_f32_16x16x16_bf16 v[108:111], v[30:31], v[148:149], v[108:111]
    v_mfma_f32_16x16x16_bf16 v[112:115], v[30:31], v[150:151], v[112:115]
    v_mfma_f32_16x16x16_bf16 v[108:111], v[32:33], v[152:153], v[108:111]
    v_mfma_f32_16x16x16_bf16 v[112:115], v[32:33], v[154:155], v[112:115]
    v_mfma_f32_16x16x16_bf16 v[108:111], v[34:35], v[156:157], v[108:111]
    v_mfma_f32_16x16x16_bf16 v[112:115], v[34:35], v[158:159], v[112:115]
    v_mfma_f32_16x16x16_bf16 v[108:111], v[36:37], v[160:161], v[108:111]
    v_mfma_f32_16x16x16_bf16 v[112:115], v[36:37], v[162:163], v[112:115]
    v_mfma_f32_16x16x16_bf16 v[108:111], v[38:39], v[164:165], v[108:111]
    v_mfma_f32_16x16x16_bf16 v[112:115], v[38:39], v[166:167], v[112:115]
    v_mfma_f32_16x16x16_bf16 v[108:111], v[40:41], v[168:169], v[108:111]
    v_mfma_f32_16x16x16_bf16 v[112:115], v[40:41], v[170:171], v[112:115]
    v_mfma_f32_16x16x16_bf16 v[108:111], v[42:43], v[172:173], v[108:111]
    v_mfma_f32_16x16x16_bf16 v[112:115], v[42:43], v[174:175], v[112:115]
    v_mfma_f32_16x16x16_bf16 v[108:111], v[44:45], v[176:177], v[108:111]
    v_mfma_f32_16x16x16_bf16 v[112:115], v[44:45], v[178:179], v[112:115]
    s_mov_b32 s23, 8000000
L_ispin3:
    ds_read_b32 v19, v18 offset:8
    s_waitcnt lgkmcnt(0)
    v_readfirstlane_b32 s33, v19
    s_cmp_eq_u32 s33, 3
    s_cbranch_scc1 L_ispin3_ok
    s_sub_u32 s23, s23, 1
    s_cbranch_scc0 L_ispin3
L_ispin3_ok:
    buffer_load_dwordx4 v[216:219], v8, s[28:31], s36 offen offset:2048 nt
    buffer_load_dwordx4 v[220:223], v8, s[28:31], s36 offen offset:3072 nt
    s_add_u32 s36, s36, 4096
    s_and_b32 s36, s36, 32767
    buffer_load_dwordx4 v[224:227], v8, s[28:31], s36 offen offset:0 nt
    buffer_load_dwordx4 v[228:231], v8, s[28:31], s36 offen offset:1024 nt
    buffer_load_dwordx4 v[232:235], v8, s[28:31], s36 offen offset:2048 nt
    buffer_load_dwordx4 v[236:239], v8, s[28:31], s36 offen offset:3072 nt
    s_add_u32 s36, s36, 4096
    s_and_b32 s36, s36, 32767
    buffer_load_dwordx4 v[240:243], v8, s[28:31], s36 offen offset:0 nt
    buffer_load_dwordx4 v[244:247], v8, s[28:31], s36 offen offset:1024 nt
    buffer_load_dwordx4 v[248:251], v8, s[28:31], s36 offen offset:2048 nt
    buffer_load_dwordx4 v[252:255], v8, s[28:31], s36 offen offset:3072 nt
    s_waitcnt vmcnt(18)
    v_mfma_f32_16x16x16_bf16 v[108:111], v[46:47], v[180:181], v[108:111]
    v_mfma_f32_16x16x16_bf16 v[112:115], v[46:47], v[182:183], v[112:115]
    s_waitcnt vmcnt(17)
    v_mfma_f32_16x16x16_bf16 v[108:111], v[48:49], v[184:185], v[108:111]
    v_mfma_f32_16x16x16_bf16 v[112:115], v[48:49], v[186:187], v[112:115]
    s_waitcnt vmcnt(16)
    v_mfma_f32_16x16x16_bf16 v[108:111], v[50:51], v[188:189], v[108:111]
    v_mfma_f32_16x16x16_bf16 v[112:115], v[50:51], v[190:191], v[112:115]
    s_waitcnt vmcnt(15)
    v_mfma_f32_16x16x16_bf16 v[108:111], v[52:53], v[192:193], v[108:111]
    v_mfma_f32_16x16x16_bf16 v[112:115], v[52:53], v[194:195], v[112:115]
    s_waitcnt vmcnt(14)
    v_mfma_f32_16x16x16_bf16 v[108:111], v[54:55], v[196:197], v[108:111]
    v_mfma_f32_16x16x16_bf16 v[112:115], v[54:55], v[198:199], v[112:115]
    s_waitcnt vmcnt(13)
    v_mfma_f32_16x16x16_bf16 v[108:111], v[56:57], v[200:201], v[108:111]
    v_mfma_f32_16x16x16_bf16 v[112:115], v[56:57], v[202:203], v[112:115]
    s_waitcnt vmcnt(12)
    v_mfma_f32_16x16x16_bf16 v[108:111], v[58:59], v[204:205], v[108:111]
    v_mfma_f32_16x16x16_bf16 v[112:115], v[58:59], v[206:207], v[112:115]
    s_waitcnt vmcnt(11)
    v_mfma_f32_16x16x16_bf16 v[108:111], v[60:61], v[208:209], v[108:111]
    v_mfma_f32_16x16x16_bf16 v[112:115], v[60:61], v[210:211], v[112:115]
    s_waitcnt vmcnt(10)
    v_mfma_f32_16x16x16_bf16 v[108:111], v[62:63], v[212:213], v[108:111]
    v_mfma_f32_16x16x16_bf16 v[112:115], v[62:63], v[214:215], v[112:115]
    s_waitcnt vmcnt(9)
    v_mfma_f32_16x16x16_bf16 v[108:111], v[64:65], v[216:217], v[108:111]
    v_mfma_f32_16x16x16_bf16 v[112:115], v[64:65], v[218:219], v[112:115]
    s_waitcnt vmcnt(8)
    v_mfma_f32_16x16x16_bf16 v[108:111], v[66:67], v[220:221], v[108:111]
    v_mfma_f32_16x16x16_bf16 v[112:115], v[66:67], v[222:223], v[112:115]
    s_waitcnt vmcnt(7)
    v_mfma_f32_16x16x16_bf16 v[108:111], v[68:69], v[224:225], v[108:111]
    v_mfma_f32_16x16x16_bf16 v[112:115], v[68:69], v[226:227], v[112:115]
    s_waitcnt vmcnt(6)
    v_mfma_f32_16x16x16_bf16 v[108:111], v[70:71], v[228:229], v[108:111]
    v_mfma_f32_16x16x16_bf16 v[112:115], v[70:71], v[230:231], v[112:115]
    s_waitcnt vmcnt(5)
    v_mfma_f32_16x16x16_bf16 v[108:111], v[72:73], v[232:233], v[108:111]
    v_mfma_f32_16x16x16_bf16 v[112:115], v[72:73], v[234:235], v[112:115]
    s_mov_b32 s23, 4000000
L_pspin:
    ds_read_b32 v19, v18 offset:12
    ds_read_b128 v[20:23], v118 offset:0
    ds_read_b128 v[24:27], v118 offset:1024
    ds_read_b128 v[28:31], v118 offset:2048
    ds_read_b128 v[32:35], v118 offset:3072
    ds_read_b128 v[36:39], v118 offset:4096
    ds_read_b128 v[40:43], v118 offset:5120
    s_sub_u32 s23, s23, 1
    s_cbranch_scc1 L_pok
    s_waitcnt lgkmcnt(6)
    v_readfirstlane_b32 s33, v19
    s_cmp_eq_u32 s33, 3
    s_cbranch_scc0 L_pspin
L_pok:
    s_waitcnt lgkmcnt(2)
    v_pk_add_f32 v[20:21], v[20:21], v[28:29]
    v_pk_add_f32 v[22:23], v[22:23], v[30:31]
    v_pk_add_f32 v[24:25], v[24:25], v[32:33]
    v_pk_add_f32 v[26:27], v[26:27], v[34:35]
    s_waitcnt lgkmcnt(0)
    v_pk_add_f32 v[108:109], v[108:109], v[36:37]
    v_pk_add_f32 v[110:111], v[110:111], v[38:39]
    v_pk_add_f32 v[112:113], v[112:113], v[40:41]
    v_pk_add_f32 v[114:115], v[114:115], v[42:43]
    v_pk_add_f32 v[108:109], v[108:109], v[20:21]
    v_pk_add_f32 v[110:111], v[110:111], v[22:23]
    v_pk_add_f32 v[112:113], v[112:113], v[24:25]
    v_pk_add_f32 v[114:115], v[114:115], v[26:27]
    s_nop 0
    s_waitcnt vmcnt(4)
    v_mfma_f32_16x16x16_bf16 v[108:111], v[74:75], v[236:237], v[108:111]
    v_mfma_f32_16x16x16_bf16 v[112:115], v[74:75], v[238:239], v[112:115]
    s_waitcnt vmcnt(3)
    v_mfma_f32_16x16x16_bf16 v[108:111], v[76:77], v[240:241], v[108:111]
    v_mfma_f32_16x16x16_bf16 v[112:115], v[76:77], v[242:243], v[112:115]
    s_waitcnt vmcnt(2)
    v_mfma_f32_16x16x16_bf16 v[108:111], v[78:79], v[244:245], v[108:111]
    v_mfma_f32_16x16x16_bf16 v[112:115], v[78:79], v[246:247], v[112:115]
    s_waitcnt vmcnt(1)
    v_mfma_f32_16x16x16_bf16 v[108:111], v[80:81], v[248:249], v[108:111]
    v_mfma_f32_16x16x16_bf16 v[112:115], v[80:81], v[250:251], v[112:115]
    s_waitcnt vmcnt(0)
    v_mfma_f32_16x16x16_bf16 v[108:111], v[82:83], v[252:253], v[108:111]
    v_mfma_f32_16x16x16_bf16 v[112:115], v[82:83], v[254:255], v[112:115]
    s_nop 6
    v_cvt_pk_bf16_f32 v52, v108, v109
    v_cvt_pk_bf16_f32 v53, v110, v111
    v_cvt_pk_bf16_f32 v54, v112, v113
    v_cvt_pk_bf16_f32 v55, v114, v115
    buffer_store_dwordx4 v[52:55], v117, s[44:47], s35 offen sc1
    buffer_store_dwordx4 v[52:55], v117, s[44:47], s37 offen sc1
L_red:
    s_mov_b32 s48, s14
    s_and_b32 s49, s15, 0xffff
    s_mov_b32 s50, 32768
    s_mov_b32 s51, 0x20000
    v_and_b32 v9, 3, v0
    v_lshrrev_b32 v4, 2, v0
    v_lshlrev_b32 v10, 8, v4
    v_lshl_add_u32 v10, v9, 4, v10
    v_lshlrev_b32 v7, 10, v1
    v_lshl_add_u32 v7, v9, 1, v7
    s_lshr_b32 s30, s21, 2
    s_lshl_b32 s30, s30, 12
    s_lshl_b32 s31, s22, 7
    s_add_u32 s30, s30, s31
    s_and_b32 s31, s21, 3
    s_lshl_b32 s31, s31, 5
    s_add_u32 s30, s30, s31
    s_lshl_b32 s31, s3, 3
    s_add_u32 s30, s30, s31
    ds_read_b96 v[20:22], v18 offset:32
    s_waitcnt lgkmcnt(0)
    v_readfirstlane_b32 s62, v20
    v_readfirstlane_b32 s63, v21
    v_readfirstlane_b32 s61, v22
    s_xor_b32 s56, s62, 0x80808080
    s_bfe_u32 s57, s56, 0x80008
    s_bfe_u32 s58, s56, 0x80010
    s_lshr_b32 s59, s56, 24
    s_and_b32 s56, s56, 0xff
    v_mov_b32 v41, 0
    s_lshl_b32 s28, s21, 16
    s_add_u32 s28, s28, s61
    s_lshl_b32 s29, s3, 6
    s_add_u32 s28, s28, s29
    s_add_u32 s29, s28, 4096
    s_mov_b32 s26, 0x000f000f
    s_mov_b32 s27, s26
    s_cmp_eq_u32 s3, 3
    s_cbranch_scc1 L_red1
    s_waitcnt vmcnt(0)
    s_mov_b64 exec, 1
    v_mov_b32 v19, 1
    ds_add_u32 v18, v19 offset:16
    s_mov_b64 exec, -1
L_red1:
    s_mov_b32 s23, 4000000
L_rspin:
    ds_read_b32 v19, v18 offset:24
    s_waitcnt lgkmcnt(0)
    v_readfirstlane_b32 s33, v19
    s_cmp_eq_u32 s33, 2
    s_cbranch_scc1 L_rspin_ok
    s_sleep 1
    s_sub_u32 s23, s23, 1
    s_cbranch_scc0 L_rspin
L_rspin_ok:
    s_mov_b32 s23, 500000
L_rpoll:
    buffer_load_dwordx4 v[24:27], v10, s[44:47], s28 offen sc1
    buffer_load_dwordx4 v[28:31], v10, s[44:47], s29 offen sc1
    s_sub_u32 s23, s23, 1
    s_cbranch_scc1 L_rok
    s_waitcnt vmcnt(1)
    v_xor_b32 v24, s56, v24
    v_xor_b32 v25, s57, v25
    v_xor_b32 v26, s58, v26
    v_xor_b32 v27, s59, v27
    v_or3_b32 v40, v24, v25, v26
    v_or_b32 v40, v40, v27
    s_waitcnt vmcnt(0)
    v_xor_b32 v28, s56, v28
    v_xor_b32 v29, s57, v29
    v_xor_b32 v30, s58, v30
    v_xor_b32 v31, s59, v31
    v_or3_b32 v40, v40, v28, v29
    v_or3_b32 v40, v40, v30, v31
    v_cmpx_ne_u32_sdwa vcc, v40, v41 src0_sel:BYTE_0 src1_sel:DWORD
    s_cbranch_execnz L_rpoll
L_rok:
    s_mov_b64 exec, -1
    v_pk_add_f32 v[24:25], v[24:25], v[28:29]
    v_pk_add_f32 v[26:27], v[26:27], v[30:31]
    s_nop 1
    v_permlane32_swap_b32 v24, v26
    v_permlane32_swap_b32 v25, v27
    s_nop 0
    v_pk_add_f32 v[24:25], v[24:25], v[26:27]
    s_nop 1
    v_permlane16_swap_b32 v24, v25
    s_nop 0
    v_add_f32 v24, v24, v25
    s_nop 1
    v_add_f32_dpp v24, v24, v24 row_ror:8 row_mask:0xf bank_mask:0xf
    s_nop 1
    v_add_f32_dpp v24, v24, v24 row_ror:4 row_mask:0xf bank_mask:0xf
    v_cvt_pk_bf16_f32 v24, v24, v24
    s_mov_b64 exec, s[26:27]
    buffer_store_short v24, v7, s[48:51], s30 offen
    s_or_b32 s33, s2, s3
    s_cmp_lg_u32 s33, 0
    s_cbranch_scc1 L_noepoch
    s_mov_b64 exec, 1
    v_mov_b32 v62, s62
    v_mov_b32 v63, 0
    buffer_store_dword v62, v63, s[44:47], 0 offen
L_noepoch:
    s_endpgm
L_s0b:
    s_mov_b32 s44, s18
    s_and_b32 s45, s19, 0xffff
    s_mov_b32 s46, 10485760
    s_mov_b32 s47, 0x20000
    v_and_b32 v4, 3, v2
    v_lshlrev_b32 v4, 2, v4
    v_lshrrev_b32 v5, 2, v2
    v_add_u32 v4, v4, v5
    v_xor_b32 v4, v4, v1
    v_lshlrev_b32 v4, 4, v4
    v_lshl_add_u32 v4, v2, 8, v4
    v_add_u32 v4, 148736, v4
    v_xor_b32 v5, 64, v4
    v_xor_b32 v6, 0x80, v4
    v_xor_b32 v7, 0xc0, v4
    v_lshlrev_b32 v10, 18, v1
    v_lshl_add_u32 v10, v2, 4, v10
    v_mov_b32 v13, 0xff
    v_lshrrev_b32 v9, 2, v2
    v_lshl_add_u32 v9, v1, 3, v9
    v_lshlrev_b32 v9, 7, v9
    v_and_b32 v19, 3, v2
    v_lshl_add_u32 v9, v19, 3, v9
    v_add_u32 v9, 131072, v9
    v_lshrrev_b32 v19, 3, v2
    v_and_b32 v14, 1, v1
    v_lshl_add_u32 v19, v14, 1, v19
    v_lshl_add_u32 v9, v19, 5, v9
    v_xor_b32 v14, 32, v9
    v_xor_b32 v15, 64, v9
    v_xor_b32 v16, 0x60, v9
    s_waitcnt vmcnt(0)
    ds_read_b128 v[24:27], v4 offset:0
    ds_read_b128 v[28:31], v5 offset:0
    ds_read_b128 v[32:35], v6 offset:0
    ds_read_b128 v[36:39], v7 offset:0
    ds_read_b128 v[40:43], v4 offset:4096
    ds_read_b128 v[44:47], v5 offset:4096
    ds_read_b128 v[48:51], v6 offset:4096
    ds_read_b128 v[52:55], v7 offset:4096
    ds_read_b64_tr_b16 v[56:57], v9 offset:0
    ds_read_b64_tr_b16 v[58:59], v9 offset:512
    ds_read_b64_tr_b16 v[60:61], v14 offset:0
    ds_read_b64_tr_b16 v[62:63], v14 offset:512
    ds_read_b64_tr_b16 v[64:65], v15 offset:0
    ds_read_b64_tr_b16 v[66:67], v15 offset:512
    ds_read_b64_tr_b16 v[68:69], v16 offset:0
    ds_read_b64_tr_b16 v[70:71], v16 offset:512
    ds_read_b64_tr_b16 v[72:73], v9 offset:4096
    ds_read_b64_tr_b16 v[74:75], v9 offset:4608
    ds_read_b64_tr_b16 v[76:77], v14 offset:4096
    ds_read_b64_tr_b16 v[78:79], v14 offset:4608
    ds_read_b64_tr_b16 v[80:81], v15 offset:4096
    ds_read_b64_tr_b16 v[82:83], v15 offset:4608
    ds_read_b64_tr_b16 v[84:85], v16 offset:4096
    ds_read_b64_tr_b16 v[86:87], v16 offset:4608
    ds_read_b64_tr_b16 v[88:89], v9 offset:8192
    ds_read_b64_tr_b16 v[90:91], v9 offset:8704
    ds_read_b64_tr_b16 v[92:93], v14 offset:8192
    ds_read_b64_tr_b16 v[94:95], v14 offset:8704
    ds_read_b64_tr_b16 v[96:97], v15 offset:8192
    ds_read_b64_tr_b16 v[98:99], v15 offset:8704
    ds_read_b64_tr_b16 v[100:101], v16 offset:8192
    ds_read_b64_tr_b16 v[102:103], v16 offset:8704
    ds_read_b64_tr_b16 v[104:105], v9 offset:12288
    ds_read_b64_tr_b16 v[106:107], v9 offset:12800
    ds_read_b64_tr_b16 v[108:109], v14 offset:12288
    ds_read_b64_tr_b16 v[110:111], v14 offset:12800
    ds_read_b64_tr_b16 v[112:113], v15 offset:12288
    ds_read_b64_tr_b16 v[114:115], v15 offset:12800
    ds_read_b64_tr_b16 v[116:117], v16 offset:12288
    ds_read_b64_tr_b16 v[118:119], v16 offset:12800
    s_waitcnt lgkmcnt(15)
    v_mfma_f32_16x16x32_bf16 v[120:123], v[24:27], v[56:59], 0
    v_mfma_f32_16x16x32_bf16 v[124:127], v[24:27], v[60:63], 0
    v_mfma_f32_16x16x32_bf16 v[128:131], v[24:27], v[64:67], 0
    v_mfma_f32_16x16x32_bf16 v[132:135], v[24:27], v[68:71], 0
    v_mfma_f32_16x16x32_bf16 v[136:139], v[40:43], v[56:59], 0
    v_mfma_f32_16x16x32_bf16 v[140:143], v[40:43], v[60:63], 0
    v_mfma_f32_16x16x32_bf16 v[144:147], v[40:43], v[64:67], 0
    v_mfma_f32_16x16x32_bf16 v[148:151], v[40:43], v[68:71], 0
    s_waitcnt lgkmcnt(15)
    v_mfma_f32_16x16x32_bf16 v[120:123], v[28:31], v[72:75], v[120:123]
    v_mfma_f32_16x16x32_bf16 v[124:127], v[28:31], v[76:79], v[124:127]
    v_mfma_f32_16x16x32_bf16 v[128:131], v[28:31], v[80:83], v[128:131]
    v_mfma_f32_16x16x32_bf16 v[132:135], v[28:31], v[84:87], v[132:135]
    v_mfma_f32_16x16x32_bf16 v[136:139], v[44:47], v[72:75], v[136:139]
    v_mfma_f32_16x16x32_bf16 v[140:143], v[44:47], v[76:79], v[140:143]
    v_mfma_f32_16x16x32_bf16 v[144:147], v[44:47], v[80:83], v[144:147]
    v_mfma_f32_16x16x32_bf16 v[148:151], v[44:47], v[84:87], v[148:151]
    s_waitcnt lgkmcnt(8)
    v_mfma_f32_16x16x32_bf16 v[120:123], v[32:35], v[88:91], v[120:123]
    v_mfma_f32_16x16x32_bf16 v[124:127], v[32:35], v[92:95], v[124:127]
    v_mfma_f32_16x16x32_bf16 v[128:131], v[32:35], v[96:99], v[128:131]
    v_mfma_f32_16x16x32_bf16 v[132:135], v[32:35], v[100:103], v[132:135]
    v_mfma_f32_16x16x32_bf16 v[136:139], v[48:51], v[88:91], v[136:139]
    v_mfma_f32_16x16x32_bf16 v[140:143], v[48:51], v[92:95], v[140:143]
    v_mfma_f32_16x16x32_bf16 v[144:147], v[48:51], v[96:99], v[144:147]
    v_mfma_f32_16x16x32_bf16 v[148:151], v[48:51], v[100:103], v[148:151]
    s_waitcnt lgkmcnt(0)
    v_mfma_f32_16x16x32_bf16 v[120:123], v[36:39], v[104:107], v[120:123]
    v_mfma_f32_16x16x32_bf16 v[124:127], v[36:39], v[108:111], v[124:127]
    v_mfma_f32_16x16x32_bf16 v[128:131], v[36:39], v[112:115], v[128:131]
    v_mfma_f32_16x16x32_bf16 v[132:135], v[36:39], v[116:119], v[132:135]
    v_mfma_f32_16x16x32_bf16 v[136:139], v[52:55], v[104:107], v[136:139]
    v_mfma_f32_16x16x32_bf16 v[140:143], v[52:55], v[108:111], v[140:143]
    v_mfma_f32_16x16x32_bf16 v[144:147], v[52:55], v[112:115], v[144:147]
    v_mfma_f32_16x16x32_bf16 v[148:151], v[52:55], v[116:119], v[148:151]
    s_mov_b32 s23, 4000000
L_hspin:
    ds_read_b32 v19, v18 offset:20
    s_waitcnt lgkmcnt(0)
    v_readfirstlane_b32 s33, v19
    s_cmp_eq_u32 s33, 1
    s_cbranch_scc1 L_hspin_ok
    s_sleep 1
    s_sub_u32 s23, s23, 1
    s_cbranch_scc0 L_hspin
L_hspin_ok:
    ds_read_b96 v[20:22], v18 offset:32
    s_waitcnt lgkmcnt(0)
    v_readfirstlane_b32 s62, v20
    v_readfirstlane_b32 s63, v21
    v_readfirstlane_b32 s61, v22
    s_mov_b32 s56, s62
    s_bfe_u32 s57, s56, 0x80008
    s_bfe_u32 s58, s56, 0x80010
    s_lshr_b32 s59, s56, 24
    s_and_b32 s56, s56, 0xff
    s_lshl_b32 s31, s21, 8
    s_add_u32 s31, s31, s61
    s_lshl_b32 s28, s21, 16
    s_add_u32 s28, s28, s61
    s_add_u32 s29, s28, 4096
    v_bfi_b32 v152, v13, s56, v120
    v_bfi_b32 v153, v13, s57, v124
    v_bfi_b32 v154, v13, s58, v128
    v_bfi_b32 v155, v13, s59, v132
    v_bfi_b32 v156, v13, s56, v121
    v_bfi_b32 v157, v13, s57, v125
    v_bfi_b32 v158, v13, s58, v129
    v_bfi_b32 v159, v13, s59, v133
    v_bfi_b32 v160, v13, s56, v122
    v_bfi_b32 v161, v13, s57, v126
    v_bfi_b32 v162, v13, s58, v130
    v_bfi_b32 v163, v13, s59, v134
    v_bfi_b32 v164, v13, s56, v123
    v_bfi_b32 v165, v13, s57, v127
    v_bfi_b32 v166, v13, s58, v131
    v_bfi_b32 v167, v13, s59, v135
    v_bfi_b32 v168, v13, s56, v136
    v_bfi_b32 v169, v13, s57, v140
    v_bfi_b32 v170, v13, s58, v144
    v_bfi_b32 v171, v13, s59, v148
    v_bfi_b32 v172, v13, s56, v137
    v_bfi_b32 v173, v13, s57, v141
    v_bfi_b32 v174, v13, s58, v145
    v_bfi_b32 v175, v13, s59, v149
    v_bfi_b32 v176, v13, s56, v138
    v_bfi_b32 v177, v13, s57, v142
    v_bfi_b32 v178, v13, s58, v146
    v_bfi_b32 v179, v13, s59, v150
    v_bfi_b32 v180, v13, s56, v139
    v_bfi_b32 v181, v13, s57, v143
    v_bfi_b32 v182, v13, s58, v147
    v_bfi_b32 v183, v13, s59, v151
    s_cmp_eq_u32 s63, 1
    s_cbranch_scc0 L_qslow
    s_add_u32 s25, s31, 0
    buffer_store_dwordx4 v[152:155], v10, s[44:47], s25 offen
    s_add_u32 s25, s31, 65536
    buffer_store_dwordx4 v[156:159], v10, s[44:47], s25 offen
    s_add_u32 s25, s31, 131072
    buffer_store_dwordx4 v[160:163], v10, s[44:47], s25 offen
    s_add_u32 s25, s31, 196608
    buffer_store_dwordx4 v[164:167], v10, s[44:47], s25 offen
    s_add_u32 s25, s31, 1048576
    buffer_store_dwordx4 v[168:171], v10, s[44:47], s25 offen
    s_add_u32 s25, s31, 1114112
    buffer_store_dwordx4 v[172:175], v10, s[44:47], s25 offen
    s_add_u32 s25, s31, 1179648
    buffer_store_dwordx4 v[176:179], v10, s[44:47], s25 offen
    s_add_u32 s25, s31, 1245184
    buffer_store_dwordx4 v[180:183], v10, s[44:47], s25 offen
    s_branch L_qst
L_qslow:
    s_add_u32 s25, s31, 0
    buffer_store_dwordx4 v[152:155], v10, s[44:47], s25 offen sc1
    s_add_u32 s25, s31, 65536
    buffer_store_dwordx4 v[156:159], v10, s[44:47], s25 offen sc1
    s_add_u32 s25, s31, 131072
    buffer_store_dwordx4 v[160:163], v10, s[44:47], s25 offen sc1
    s_add_u32 s25, s31, 196608
    buffer_store_dwordx4 v[164:167], v10, s[44:47], s25 offen sc1
    s_add_u32 s25, s31, 1048576
    buffer_store_dwordx4 v[168:171], v10, s[44:47], s25 offen sc1
    s_add_u32 s25, s31, 1114112
    buffer_store_dwordx4 v[172:175], v10, s[44:47], s25 offen sc1
    s_add_u32 s25, s31, 1179648
    buffer_store_dwordx4 v[176:179], v10, s[44:47], s25 offen sc1
    s_add_u32 s25, s31, 1245184
    buffer_store_dwordx4 v[180:183], v10, s[44:47], s25 offen sc1
L_qst:
    s_mov_b32 s23, 2666666
L_qtrig:
    ds_read_b32 v19, v18 offset:28
    s_waitcnt lgkmcnt(0)
    v_readfirstlane_b32 s33, v19
    s_cmp_eq_u32 s33, 6
    s_cbranch_scc1 L_qtrig_ok
    s_sleep 2
    s_sub_u32 s23, s23, 1
    s_cbranch_scc0 L_qtrig
L_qtrig_ok:
    s_mov_b32 s23, 500000
L_qpoll:
    s_sub_u32 s23, s23, 1
    s_cbranch_scc1 L_qok
    buffer_load_dwordx4 v[24:27], v8, s[44:47], s28 offen offset:0 sc1
    buffer_load_dwordx4 v[28:31], v8, s[44:47], s28 offen offset:1024 sc1
    buffer_load_dwordx4 v[32:35], v8, s[44:47], s28 offen offset:2048 sc1
    buffer_load_dwordx4 v[36:39], v8, s[44:47], s28 offen offset:3072 sc1
    buffer_load_dwordx4 v[40:43], v8, s[44:47], s29 offen offset:0 sc1
    buffer_load_dwordx4 v[44:47], v8, s[44:47], s29 offen offset:1024 sc1
    buffer_load_dwordx4 v[48:51], v8, s[44:47], s29 offen offset:2048 sc1
    buffer_load_dwordx4 v[52:55], v8, s[44:47], s29 offen offset:3072 sc1
    s_waitcnt vmcnt(0)
    v_xor_b32 v24, s56, v24
    v_xor_b32 v25, s57, v25
    v_xor_b32 v26, s58, v26
    v_xor_b32 v27, s59, v27
    v_or3_b32 v60, v24, v25, v26
    v_or_b32 v60, v60, v27
    v_xor_b32 v28, s56, v28
    v_xor_b32 v29, s57, v29
    v_xor_b32 v30, s58, v30
    v_xor_b32 v31, s59, v31
    v_or3_b32 v60, v60, v28, v29
    v_or3_b32 v60, v60, v30, v31
    v_xor_b32 v32, s56, v32
    v_xor_b32 v33, s57, v33
    v_xor_b32 v34, s58, v34
    v_xor_b32 v35, s59, v35
    v_or3_b32 v60, v60, v32, v33
    v_or3_b32 v60, v60, v34, v35
    v_xor_b32 v36, s56, v36
    v_xor_b32 v37, s57, v37
    v_xor_b32 v38, s58, v38
    v_xor_b32 v39, s59, v39
    v_or3_b32 v60, v60, v36, v37
    v_or3_b32 v60, v60, v38, v39
    v_xor_b32 v40, s56, v40
    v_xor_b32 v41, s57, v41
    v_xor_b32 v42, s58, v42
    v_xor_b32 v43, s59, v43
    v_or3_b32 v60, v60, v40, v41
    v_or3_b32 v60, v60, v42, v43
    v_xor_b32 v44, s56, v44
    v_xor_b32 v45, s57, v45
    v_xor_b32 v46, s58, v46
    v_xor_b32 v47, s59, v47
    v_or3_b32 v60, v60, v44, v45
    v_or3_b32 v60, v60, v46, v47
    v_xor_b32 v48, s56, v48
    v_xor_b32 v49, s57, v49
    v_xor_b32 v50, s58, v50
    v_xor_b32 v51, s59, v51
    v_or3_b32 v60, v60, v48, v49
    v_or3_b32 v60, v60, v50, v51
    v_xor_b32 v52, s56, v52
    v_xor_b32 v53, s57, v53
    v_xor_b32 v54, s58, v54
    v_xor_b32 v55, s59, v55
    v_or3_b32 v60, v60, v52, v53
    v_or3_b32 v60, v60, v54, v55
    v_and_b32 v60, 0xff, v60
    v_cmpx_ne_u32 vcc, 0, v60
    s_cbranch_execnz L_qpoll
L_qok:
    s_mov_b64 exec, -1
    v_pk_add_f32 v[24:25], v[24:25], v[32:33]
    v_pk_add_f32 v[40:41], v[40:41], v[48:49]
    v_pk_add_f32 v[24:25], v[24:25], v[40:41]
    v_pk_add_f32 v[26:27], v[26:27], v[34:35]
    v_pk_add_f32 v[42:43], v[42:43], v[50:51]
    v_pk_add_f32 v[26:27], v[26:27], v[42:43]
    v_pk_add_f32 v[28:29], v[28:29], v[36:37]
    v_pk_add_f32 v[44:45], v[44:45], v[52:53]
    v_pk_add_f32 v[28:29], v[28:29], v[44:45]
    v_pk_add_f32 v[30:31], v[30:31], v[38:39]
    v_pk_add_f32 v[46:47], v[46:47], v[54:55]
    v_pk_add_f32 v[30:31], v[30:31], v[46:47]
    v_lshlrev_b32 v11, 7, v1
    v_lshl_add_u32 v11, v2, 1, v11
    v_add_u32 v11, 147456, v11
    v_cvt_pk_bf16_f32 v60, v24, v25
    v_cvt_pk_bf16_f32 v61, v26, v27
    ds_write_b16 v11, v60 offset:0
    ds_write_b16_d16_hi v11, v60 offset:32
    ds_write_b16 v11, v61 offset:64
    ds_write_b16_d16_hi v11, v61 offset:96
    v_cvt_pk_bf16_f32 v60, v28, v29
    v_cvt_pk_bf16_f32 v61, v30, v31
    ds_write_b16 v11, v60 offset:512
    ds_write_b16_d16_hi v11, v60 offset:544
    ds_write_b16 v11, v61 offset:576
    ds_write_b16_d16_hi v11, v61 offset:608
    v_mov_b32 v19, 1
    ds_write_b32 v18, v19 offset:0
    s_lshl_b32 s40, s22, 8
    s_add_u32 s40, s40, 8320
    s_lshl_b32 s41, s21, 2
    s_add_u32 s41, s41, s40
    v_lshlrev_b32 v21, 2, v0
    ds_read_b32 v23, v18 offset:56
    s_lshl_b32 s61, s62, 1
    s_waitcnt lgkmcnt(0)
    v_or_b32 v23, s61, v23
    s_mov_b64 exec, 1
    s_cmp_eq_u32 s63, 1
    s_cbranch_scc0 L_rdy2
    buffer_store_dword v23, v8, s[44:47], s41 offen
    s_branch L_rdy3
L_rdy2:
    buffer_store_dword v23, v8, s[44:47], s41 offen sc1
L_rdy3:
    s_mov_b32 exec_lo, -1
    s_cmp_lg_u32 s21, 0
    s_cbranch_scc1 L_end
    s_mov_b32 s23, 500000
L_lb:
    s_sleep 8
    buffer_load_dword v22, v21, s[44:47], s40 offen sc1
    s_sub_u32 s23, s23, 1
    s_cbranch_scc1 L_end
    s_waitcnt vmcnt(0)
    v_and_b32 v22, -2, v22
    v_cmp_ne_u32 vcc, s61, v22
    s_cbranch_vccnz L_lb
    s_lshl_b32 s41, s22, 2
    s_add_u32 s41, s41, 4096
    s_mov_b64 exec, 1
    buffer_store_dword v20, v8, s[44:47], s41 offen sc1
    s_endpgm
L_cb:
    s_mov_b32 exec_lo, -1
    v_lshlrev_b32 v21, 2, v0
    s_mov_b32 s57, 0xf7ffffff
    s_mov_b32 s63, 1
    s_mov_b32 s23, 16
L_hp:
    s_sub_u32 s23, s23, 1
    s_cbranch_scc0 L_hp1
    s_cmp_eq_u32 s63, 0
    s_cbranch_scc1 L_hok
    s_mov_b32 s63, 0
    s_mov_b32 s57, 0x07ffffff
    s_mov_b32 s23, 500000
    s_mov_b64 exec, 1
    buffer_store_dword v20, v8, s[44:47], s41 offen sc1
    s_mov_b32 exec_lo, -1
L_hp1:
    buffer_load_dword v22, v21, s[44:47], s40 offen sc1
    s_waitcnt vmcnt(0)
    v_xor_b32 v23, s56, v22
    v_and_b32 v23, s57, v23
    v_cmp_ne_u32 vcc, 0, v23
    s_cbranch_vccnz L_hp
L_hok:
    s_waitcnt lgkmcnt(0)
    v_bfe_u32 v23, v22, 27, 1
    v_cmp_eq_u32 vcc, 1, v23
    s_and_b32 s42, vcc_lo, 0xaaaaaaaa
    s_and_b32 s43, vcc_lo, 0x55555555
    s_bcnt1_i32_b32 s42, s42
    s_bcnt1_i32_b32 s43, s43
    s_cmp_gt_u32 s42, s43
    s_cselect_b32 s61, 8192, 0
    s_add_u32 s61, s61, s52
    s_mov_b64 exec, -1
    v_mov_b32 v20, s62
    v_mov_b32 v21, s63
    v_mov_b32 v22, s61
    v_mov_b32 v19, 1
    ds_write_b96 v18, v[20:22] offset:32
    ds_write_b32 v18, v19 offset:20
L_c1:
    s_setprio 0
    s_waitcnt vmcnt(0)
    s_mov_b64 exec, 1
    v_mov_b32 v19, 1
    ds_add_u32 v18, v19 offset:28
    s_mov_b64 exec, -1
    s_lshl_b32 s33, s36, 15
    v_lshrrev_b32 v4, 3, v0
    v_and_b32 v5, 7, v0
    v_lshlrev_b32 v5, 4, v5
    v_lshl_add_u32 v17, v4, 8, v5
    v_mul_u32_u24 v11, 272, v4
    v_add3_u32 v11, v11, v5, s33
    v_mul_u32_u24 v12, 272, v2
    v_lshl_add_u32 v12, v1, 4, v12
    v_add_u32 v12, s33, v12
    v_lshlrev_b32 v10, 18, v1
    v_lshl_add_u32 v10, v2, 4, v10
    v_mov_b32 v13, 0xff
    v_lshrrev_b32 v9, 2, v2
    v_lshl_add_u32 v9, v1, 3, v9
    v_lshlrev_b32 v9, 7, v9
    v_and_b32 v19, 3, v2
    v_lshl_add_u32 v9, v19, 3, v9
    v_add_u32 v9, 131072, v9
    v_lshrrev_b32 v19, 3, v2
    v_and_b32 v14, 1, v1
    v_lshl_add_u32 v19, v14, 1, v19
    v_lshl_add_u32 v9, v19, 5, v9
    v_xor_b32 v14, 32, v9
    v_xor_b32 v15, 64, v9
    v_xor_b32 v16, 0x60, v9
    s_cmp_eq_u32 s36, 1
    s_cbranch_scc0 L_nork
    s_lshl_b32 s40, s22, 8
    s_add_u32 s40, s40, 12288
    s_lshl_b32 s41, s21, 2
    s_add_u32 s41, s41, s40
    s_add_u32 s20, s20, 0x3c6ef375
    v_mov_b32 v20, s20
    v_lshlrev_b32 v21, 2, v0
    s_mov_b32 s23, 4000000
L_cp0:
    ds_read_b32 v19, v18 offset:48
    s_waitcnt lgkmcnt(0)
    v_readfirstlane_b32 s33, v19
    s_cmp_ge_u32 s33, 4
    s_cbranch_scc1 L_cp0_ok
    s_sleep 1
    s_sub_u32 s23, s23, 1
    s_cbranch_scc0 L_cp0
L_cp0_ok:
    s_mov_b32 exec_hi, 0
    buffer_load_dword v22, v21, s[44:47], s40 offen sc1
    s_mov_b64 exec, 1
    buffer_store_dword v20, v8, s[44:47], s41 offen
    s_mov_b32 exec_lo, -1
    s_waitcnt vmcnt(1)
    v_subrev_u32 v23, s20, v22
    v_cmp_gt_u32 vcc, 1, v23
    s_mov_b64 exec, -1
    s_bcnt1_i32_b64 s42, vcc
    s_cmp_lt_u32 s42, 10
    s_cselect_b32 s43, 3, 0
    s_cmp_ge_u32 s42, 22
    s_cselect_b32 s43, 1, s43
    v_mov_b32 v19, s43
    ds_write_b32 v18, v19 offset:52
L_nork:
    s_mov_b32 s23, 1142857
L_ispin:
    ds_read_b32 v19, v18 offset:8
    s_waitcnt lgkmcnt(0)
    v_readfirstlane_b32 s33, v19
    s_cmp_eq_u32 s33, 3
    s_cbranch_scc1 L_ispin_ok
    s_sleep 6
    s_sub_u32 s23, s23, 1
    s_cbranch_scc0 L_ispin
L_ispin_ok:
    ds_read_b96 v[20:22], v18 offset:32
    s_waitcnt lgkmcnt(0)
    v_readfirstlane_b32 s62, v20
    v_readfirstlane_b32 s63, v21
    v_readfirstlane_b32 s61, v22
    s_xor_b32 s56, s62, 0x80808080
    s_lshr_b32 s57, s56, 8
    s_lshr_b32 s58, s56, 16
    s_lshr_b32 s59, s56, 24
    s_lshl_b32 s37, s21, 14
    s_lshl_b32 s38, s36, 12
    s_add_u32 s37, s37, s38
    s_add_u32 s37, s37, 4194304
    s_lshl_b32 s48, s36, 20
    s_lshl_b32 s33, s21, 8
    s_add_u32 s48, s48, s33
    s_add_u32 s48, s48, s61
    s_add_u32 s49, s48, 65536
    s_add_u32 s50, s48, 131072
    s_add_u32 s51, s48, 196608
    s_setprio 2
    v_lshlrev_b32 v21, 2, v0
    s_lshl_b32 s33, s22, 8
    s_add_u32 s33, s33, 4096
    s_mov_b32 exec_lo, 0
    v_add_u32 v21, s33, v21
    s_mov_b32 s33, 4096
    s_mov_b32 exec_lo, 0xff
    s_mov_b32 s23, 500000
L_gr:
    s_sub_u32 s23, s23, 1
    s_cbranch_scc1 L_grok
    buffer_load_dword v22, v21, s[44:47], s33 offen sc1
    s_waitcnt vmcnt(0)
    v_cmp_ne_u32 vcc, s62, v22
    s_cmp_lg_u32 vcc_lo, 0
    s_cbranch_scc1 L_gr
L_grok:
    v_and_b32 v22, 1, v22
    v_cmp_eq_u32 vcc, 1, v22
    s_and_b32 s42, vcc_hi, 0xaaaaaaaa
    s_and_b32 s43, vcc_hi, 0x55555555
    s_bcnt1_i32_b32 s42, s42
    s_bcnt1_i32_b32 s43, s43
    s_cmp_gt_u32 s42, s43
    s_cselect_b32 s60, 8192, 0
    s_add_u32 s37, s37, s60
    s_mov_b64 exec, -1
    s_mov_b32 s23, 8000000
L_wspin0:
    ds_read_b32 v19, v18 offset:16
    s_waitcnt lgkmcnt(0)
    v_readfirstlane_b32 s33, v19
    s_cmp_ge_u32 s33, 1
    s_cbranch_scc1 L_wspin0_ok
    s_sub_u32 s23, s23, 1
    s_cbranch_scc0 L_wspin0
L_wspin0_ok:
    buffer_load_dwordx4 v[24:27], v17, s[44:47], s37 offen offset:0 sc1
    buffer_load_dwordx4 v[28:31], v17, s[44:47], s37 offen offset:128 sc1
    buffer_load_dwordx4 v[32:35], v17, s[44:47], s37 offen offset:2048 sc1
    buffer_load_dwordx4 v[36:39], v17, s[44:47], s37 offen offset:2176 sc1
    s_mov_b32 s23, 8000000
L_wspin:
    ds_read_b32 v19, v18 offset:16
    s_waitcnt lgkmcnt(0)
    v_readfirstlane_b32 s33, v19
    s_cmp_eq_u32 s33, 3
    s_cbranch_scc1 L_wspin_ok
    s_sub_u32 s23, s23, 1
    s_cbranch_scc0 L_wspin
L_wspin_ok:
    ds_read_b64_tr_b16 v[56:57], v9 offset:0
    ds_read_b64_tr_b16 v[58:59], v9 offset:512
    ds_read_b64_tr_b16 v[60:61], v14 offset:0
    ds_read_b64_tr_b16 v[62:63], v14 offset:512
    ds_read_b64_tr_b16 v[64:65], v15 offset:0
    ds_read_b64_tr_b16 v[66:67], v15 offset:512
    ds_read_b64_tr_b16 v[68:69], v16 offset:0
    ds_read_b64_tr_b16 v[70:71], v16 offset:512
    ds_read_b64_tr_b16 v[72:73], v9 offset:4096
    ds_read_b64_tr_b16 v[74:75], v9 offset:4608
    ds_read_b64_tr_b16 v[76:77], v14 offset:4096
    ds_read_b64_tr_b16 v[78:79], v14 offset:4608
    ds_read_b64_tr_b16 v[80:81], v15 offset:4096
    ds_read_b64_tr_b16 v[82:83], v15 offset:4608
    ds_read_b64_tr_b16 v[84:85], v16 offset:4096
    ds_read_b64_tr_b16 v[86:87], v16 offset:4608
    ds_read_b64_tr_b16 v[88:89], v9 offset:8192
    ds_read_b64_tr_b16 v[90:91], v9 offset:8704
    ds_read_b64_tr_b16 v[92:93], v14 offset:8192
    ds_read_b64_tr_b16 v[94:95], v14 offset:8704
    ds_read_b64_tr_b16 v[96:97], v15 offset:8192
    ds_read_b64_tr_b16 v[98:99], v15 offset:8704
    ds_read_b64_tr_b16 v[100:101], v16 offset:8192
    ds_read_b64_tr_b16 v[102:103], v16 offset:8704
    ds_read_b64_tr_b16 v[104:105], v9 offset:12288
    ds_read_b64_tr_b16 v[106:107], v9 offset:12800
    ds_read_b64_tr_b16 v[108:109], v14 offset:12288
    ds_read_b64_tr_b16 v[110:111], v14 offset:12800
    ds_read_b64_tr_b16 v[112:113], v15 offset:12288
    ds_read_b64_tr_b16 v[114:115], v15 offset:12800
    ds_read_b64_tr_b16 v[116:117], v16 offset:12288
    ds_read_b64_tr_b16 v[118:119], v16 offset:12800
    s_mov_b32 s23, 500000
    s_branch L_pc1
L_pb:
    s_sub_u32 s23, s23, 1
    s_cbranch_scc1 L_ook
    buffer_load_dwordx4 v[24:27], v17, s[44:47], s37 offen offset:0 sc1
    buffer_load_dwordx4 v[28:31], v17, s[44:47], s37 offen offset:128 sc1
    buffer_load_dwordx4 v[32:35], v17, s[44:47], s37 offen offset:2048 sc1
    buffer_load_dwordx4 v[36:39], v17, s[44:47], s37 offen offset:2176 sc1
L_pc1:
    s_waitcnt vmcnt(3)
    v_max3_u32 v40, v24, v25, v26
    v_max_u32 v40, v40, v27
    s_waitcnt vmcnt(2)
    v_max3_u32 v40, v40, v28, v29
    v_max3_u32 v40, v40, v30, v31
    s_waitcnt vmcnt(1)
    v_max3_u32 v40, v40, v32, v33
    v_max3_u32 v40, v40, v34, v35
    s_waitcnt vmcnt(0)
    v_max3_u32 v40, v40, v36, v37
    v_max3_u32 v40, v40, v38, v39
    v_cmpx_eq_u32 vcc, -1, v40
    s_cbranch_execnz L_pb
L_ook:
    s_mov_b64 exec, -1
    ds_write_b128 v11, v[24:27] offset:0
    ds_write_b128 v11, v[32:35] offset:2176
    ds_read_b128 v[40:43], v12 offset:0
    ds_read_b128 v[44:47], v12 offset:64
    ds_write_b128 v11, v[28:31] offset:128
    ds_write_b128 v11, v[36:39] offset:2304
    ds_read_b128 v[48:51], v12 offset:128
    ds_read_b128 v[52:55], v12 offset:192
    s_cmp_eq_u32 s63, 1
    s_cbranch_scc0 L_slow
    s_waitcnt lgkmcnt(5)
    v_mfma_f32_16x16x32_bf16 v[120:123], v[40:43], v[56:59], 0
    v_mfma_f32_16x16x32_bf16 v[124:127], v[40:43], v[60:63], 0
    s_waitcnt lgkmcnt(4)
    v_mfma_f32_16x16x32_bf16 v[120:123], v[44:47], v[72:75], v[120:123]
    v_mfma_f32_16x16x32_bf16 v[124:127], v[44:47], v[76:79], v[124:127]
    s_waitcnt lgkmcnt(1)
    v_mfma_f32_16x16x32_bf16 v[120:123], v[48:51], v[88:91], v[120:123]
    s_waitcnt lgkmcnt(0)
    v_mfma_f32_16x16x32_bf16 v[120:123], v[52:55], v[104:107], v[120:123]
    v_mfma_f32_16x16x32_bf16 v[124:127], v[48:51], v[92:95], v[124:127]
    s_nop 1
    v_mfma_f32_16x16x32_bf16 v[124:127], v[52:55], v[108:111], v[124:127]
    s_nop 1
    v_mfma_f32_16x16x32_bf16 v[128:131], v[40:43], v[64:67], 0
    s_nop 0
    v_bfi_b32 v120, v13, s56, v120
    v_mfma_f32_16x16x32_bf16 v[128:131], v[44:47], v[80:83], v[128:131]
    v_bfi_b32 v121, v13, s57, v121
    v_bfi_b32 v122, v13, s58, v122
    v_mfma_f32_16x16x32_bf16 v[128:131], v[48:51], v[96:99], v[128:131]
    v_bfi_b32 v123, v13, s59, v123
    buffer_store_dwordx4 v[120:123], v10, s[44:47], s48 offen
    v_mfma_f32_16x16x32_bf16 v[128:131], v[52:55], v[112:115], v[128:131]
    v_bfi_b32 v124, v13, s56, v124
    v_bfi_b32 v125, v13, s57, v125
    v_mfma_f32_16x16x32_bf16 v[132:135], v[40:43], v[68:71], 0
    v_bfi_b32 v126, v13, s58, v126
    v_bfi_b32 v127, v13, s59, v127
    v_mfma_f32_16x16x32_bf16 v[132:135], v[44:47], v[84:87], v[132:135]
    buffer_store_dwordx4 v[124:127], v10, s[44:47], s49 offen
    v_mfma_f32_16x16x32_bf16 v[132:135], v[48:51], v[100:103], v[132:135]
    v_bfi_b32 v128, v13, s56, v128
    v_bfi_b32 v129, v13, s57, v129
    v_mfma_f32_16x16x32_bf16 v[132:135], v[52:55], v[116:119], v[132:135]
    v_bfi_b32 v130, v13, s58, v130
    v_bfi_b32 v131, v13, s59, v131
    buffer_store_dwordx4 v[128:131], v10, s[44:47], s50 offen
    s_nop 4
    v_bfi_b32 v132, v13, s56, v132
    v_bfi_b32 v133, v13, s57, v133
    v_bfi_b32 v134, v13, s58, v134
    v_bfi_b32 v135, v13, s59, v135
    buffer_store_dwordx4 v[132:135], v10, s[44:47], s51 offen
    s_branch L_pubd
L_slow:
    s_waitcnt lgkmcnt(5)
    v_mfma_f32_16x16x32_bf16 v[120:123], v[40:43], v[56:59], 0
    v_mfma_f32_16x16x32_bf16 v[124:127], v[40:43], v[60:63], 0
    s_waitcnt lgkmcnt(4)
    v_mfma_f32_16x16x32_bf16 v[120:123], v[44:47], v[72:75], v[120:123]
    v_mfma_f32_16x16x32_bf16 v[124:127], v[44:47], v[76:79], v[124:127]
    s_waitcnt lgkmcnt(1)
    v_mfma_f32_16x16x32_bf16 v[120:123], v[48:51], v[88:91], v[120:123]
    s_waitcnt lgkmcnt(0)
    v_mfma_f32_16x16x32_bf16 v[120:123], v[52:55], v[104:107], v[120:123]
    v_mfma_f32_16x16x32_bf16 v[124:127], v[48:51], v[92:95], v[124:127]
    s_nop 1
    v_mfma_f32_16x16x32_bf16 v[124:127], v[52:55], v[108:111], v[124:127]
    s_nop 1
    v_mfma_f32_16x16x32_bf16 v[128:131], v[40:43], v[64:67], 0
    s_nop 0
    v_bfi_b32 v120, v13, s56, v120
    v_mfma_f32_16x16x32_bf16 v[128:131], v[44:47], v[80:83], v[128:131]
    v_bfi_b32 v121, v13, s57, v121
    v_bfi_b32 v122, v13, s58, v122
    v_mfma_f32_16x16x32_bf16 v[128:131], v[48:51], v[96:99], v[128:131]
    v_bfi_b32 v123, v13, s59, v123
    buffer_store_dwordx4 v[120:123], v10, s[44:47], s48 offen sc1
    v_mfma_f32_16x16x32_bf16 v[128:131], v[52:55], v[112:115], v[128:131]
    v_bfi_b32 v124, v13, s56, v124
    v_bfi_b32 v125, v13, s57, v125
    v_mfma_f32_16x16x32_bf16 v[132:135], v[40:43], v[68:71], 0
    v_bfi_b32 v126, v13, s58, v126
    v_bfi_b32 v127, v13, s59, v127
    v_mfma_f32_16x16x32_bf16 v[132:135], v[44:47], v[84:87], v[132:135]
    buffer_store_dwordx4 v[124:127], v10, s[44:47], s49 offen sc1
    v_mfma_f32_16x16x32_bf16 v[132:135], v[48:51], v[100:103], v[132:135]
    v_bfi_b32 v128, v13, s56, v128
    v_bfi_b32 v129, v13, s57, v129
    v_mfma_f32_16x16x32_bf16 v[132:135], v[52:55], v[116:119], v[132:135]
    v_bfi_b32 v130, v13, s58, v130
    v_bfi_b32 v131, v13, s59, v131
    buffer_store_dwordx4 v[128:131], v10, s[44:47], s50 offen sc1
    s_nop 4
    v_bfi_b32 v132, v13, s56, v132
    v_bfi_b32 v133, v13, s57, v133
    v_bfi_b32 v134, v13, s58, v134
    v_bfi_b32 v135, v13, s59, v135
    buffer_store_dwordx4 v[132:135], v10, s[44:47], s51 offen sc1
L_pubd:
    s_mov_b64 exec, 1
    v_mov_b32 v19, 1
    ds_add_u32 v18, v19 offset:24
    s_mov_b64 exec, -1
L_end:
    s_endpgm
L_codeend:
.section .rodata,"a"
.p2align 6
.amdhsa_kernel standalone__sliding_block_cached__sampling_kernel
  .amdhsa_next_free_vgpr 256
  .amdhsa_next_free_sgpr 96
  .amdhsa_accum_offset 256
  .amdhsa_group_segment_fixed_size 0
  .amdhsa_kernarg_size 64
  .amdhsa_user_sgpr_count 2
  .amdhsa_user_sgpr_kernarg_segment_ptr 1
  .amdhsa_system_sgpr_workgroup_id_x 1
.end_amdhsa_kernel
```
